```python
import torch

def _softmax(x, axis=-1):
    return torch.softmax(x, dim=axis)
def _gelu(x):
    return torch.nn.functional.gelu(x, approximate="tanh")
def _silu(x):
    return torch.nn.functional.silu(x)
def _sigmoid(x):
    return torch.sigmoid(x)
def _layernorm(x, axis=-1, eps=1e-5):
    m = x.mean(dim=axis, keepdim=True)
    v = x.var(dim=axis, keepdim=True, unbiased=False)
    return (x - m) / torch.sqrt(v + eps)
def _scatter_add(tgt, idx, src, axis=0):
    return tgt.clone().index_add_(axis, idx, src)
def _segment_sum(src, seg, n):
    out = torch.zeros((n,) + src.shape[1:], dtype=src.dtype)
    return out.index_add_(0, seg, src)
def _pad(x, pw):
    flat = tuple(v for pair in reversed(pw) for v in pair)
    return torch.nn.functional.pad(x, flat)

kernel_name = 'recurrent_scan__spectral_fnet__swiglu_ffn__prompt'

def setup_inputs():

    _w = (lambda a: (lambda t: t.to(torch.bfloat16) if t.is_floating_point() else t)(torch.as_tensor(a)))
    def _A_setup():
        B, S, D = 1, 2048, 576
        ns = torch.arange(S)[:, None] * torch.arange(S)[None, :]
        nd = torch.arange(D)[:, None] * torch.arange(D)[None, :]
        Ws_re = torch.cos(-2.0 * torch.pi * ns / S).to(float)
        Ws_im = torch.sin(-2.0 * torch.pi * ns / S).to(float)
        Wd_re = torch.cos(-2.0 * torch.pi * nd / D).to(float)
        Wd_im = torch.sin(-2.0 * torch.pi * nd / D).to(float)
        return {
            "x": _w((lambda *s: torch.randn(*s, dtype=torch.bfloat16) * 0.05)(B, S, D)),
            "dft_seq_re": _w(Ws_re),
            "dft_seq_im": _w(Ws_im),
            "dft_hid_re": _w(Wd_re),
            "dft_hid_im": _w(Wd_im),
        }
    _A_in = _A_setup()

    def _B_setup():
        B, S, D, F = 1, 2048, 576, 4608
        return {
            "x": _w((lambda *s: torch.randn(*s, dtype=torch.bfloat16) * 0.05)(B, S, D)),
            "w_gate": _w((lambda *s: torch.randn(*s, dtype=torch.bfloat16) * 0.05)(D, F)),
            "w_up": _w((lambda *s: torch.randn(*s, dtype=torch.bfloat16) * 0.05)(D, F)),
            "w_down": _w((lambda *s: torch.randn(*s, dtype=torch.bfloat16) * 0.05)(F, D)),
        }
    _B_in = _B_setup()

    return {
        "A_x": _A_in["x"],
        "A_dft_seq_re": _A_in["dft_seq_re"],
        "A_dft_seq_im": _A_in["dft_seq_im"],
        "A_dft_hid_re": _A_in["dft_hid_re"],
        "A_dft_hid_im": _A_in["dft_hid_im"],
        "B_x": _B_in["x"],
        "B_w_gate": _B_in["w_gate"],
        "B_w_up": _B_in["w_up"],
        "B_w_down": _B_in["w_down"],
    }

def reference(A_x, A_dft_seq_re, A_dft_seq_im, A_dft_hid_re, A_dft_hid_im, B_x, B_w_gate, B_w_up, B_w_down):
    def _A_ref(x, dft_seq_re, dft_seq_im, dft_hid_re, dft_hid_im):
        a = torch.einsum("bsd,ed->bse", x, dft_hid_re)
        b = torch.einsum("bsd,ed->bse", x, dft_hid_im)
        y = torch.einsum("ts,bse->bte", dft_seq_re, a) - torch.einsum("ts,bse->bte", dft_seq_im, b)
        return y

    def _B_ref(x, w_gate, w_up, w_down):
        g = _silu(x @ w_gate)
        u = x @ w_up
        return (g * u) @ w_down

    x = A_x
    xn = _layernorm(x, axis=-1)
    s = _A_ref(xn, A_dft_seq_re, A_dft_seq_im, A_dft_hid_re, A_dft_hid_im)
    g = _silu(_B_ref(xn, B_w_gate, B_w_up, B_w_down))
    return x + s * g
```

```asm
; @launch grid=(256,1,1) block=(256,1,1) lds=153600
.amdgcn_target "amdgcn-amd-amdhsa--gfx950"
.text
.globl recurrent_scan__spectral_fnet__swiglu_ffn__prompt_kernel
.p2align 8
.type recurrent_scan__spectral_fnet__swiglu_ffn__prompt_kernel,@function
recurrent_scan__spectral_fnet__swiglu_ffn__prompt_kernel:
    s_cmp_ge_u32 s2, 256
    s_cbranch_scc1 L_recurrent_scan__spectral_fnet__swiglu_ffn__prompt_kernel_end_1
    s_load_dwordx2 s[60:61], s[0:1], 0
    s_load_dwordx4 s[64:67], s[0:1], 24
    s_load_dwordx4 s[68:71], s[0:1], 48
    s_load_dwordx2 s[24:25], s[0:1], 64
    s_load_dwordx2 s[72:73], s[0:1], 88
    s_load_dwordx2 s[34:35], s[0:1], 80
    s_getpc_b64 s[28:29]
L_recurrent_scan__spectral_fnet__swiglu_ffn__prompt_kernel_pc0_2:
    v_lshlrev_b32 v102, 7, v0
    v_min_u32 v102, L_recurrent_scan__spectral_fnet__swiglu_ffn__prompt_kernel_end_1-L_recurrent_scan__spectral_fnet__swiglu_ffn__prompt_kernel_pc0_2, v102
    v_mov_b32 v103, s29
    v_add_co_u32 v102, vcc, s28, v102
    s_nop 1
    v_addc_co_u32 v103, vcc, 0, v103, vcc
    global_load_dword v4, v[102:103], off
    s_and_b32 s3, s2, 7
    s_lshr_b32 s4, s2, 3
    v_and_b32 v11, 63, v0
    v_lshrrev_b32 v15, 6, v0
    v_and_b32 v13, 15, v11
    v_readfirstlane_b32 s5, v15
    v_lshrrev_b32 v14, 4, v11
    s_lshl_b32 s6, s4, 4
    s_add_u32 s7, s5, 1
    s_lshr_b32 s7, s7, 1
    s_lshl_b32 s7, s7, 10
    s_cmp_ge_u32 s5, 2
    s_cselect_b32 s38, 512, 0
    v_add_u32 v15, s6, v13
    s_bitcmp1_b32 s5, 0
    s_cselect_b64 vcc, -1, 0
    v_sub_u32 v104, s7, v15
    v_add_u32 v105, s7, v15
    v_cndmask_b32 v104, v105, v104, vcc
    v_cmp_eq_u32 vcc, 0, v15
    v_mov_b32 v105, s38
    s_nop 0
    v_cndmask_b32 v105, 0, v105, vcc
    v_sub_u32 v104, v104, v105
    v_mul_u32_u24 v104, 0x480, v104
    v_lshlrev_b32 v105, 4, v14
    v_add_u32 v104, v104, v105
    s_waitcnt lgkmcnt(0)
    s_mov_b32 s8, s60
    s_mov_b32 s9, s61
    s_mov_b32 s10, 2359296
    s_mov_b32 s11, 0x00020000
    buffer_load_dwordx4 v[184:187], v104, s[8:11], 0 offen offset:0
    buffer_load_dwordx4 v[188:191], v104, s[8:11], 0 offen offset:64
    buffer_load_dwordx4 v[192:195], v104, s[8:11], 0 offen offset:128
    buffer_load_dwordx4 v[196:199], v104, s[8:11], 0 offen offset:192
    buffer_load_dwordx4 v[200:203], v104, s[8:11], 0 offen offset:256
    buffer_load_dwordx4 v[204:207], v104, s[8:11], 0 offen offset:320
    buffer_load_dwordx4 v[208:211], v104, s[8:11], 0 offen offset:384
    buffer_load_dwordx4 v[212:215], v104, s[8:11], 0 offen offset:448
    buffer_load_dwordx4 v[216:219], v104, s[8:11], 0 offen offset:512
    buffer_load_dwordx4 v[220:223], v104, s[8:11], 0 offen offset:576
    buffer_load_dwordx4 v[224:227], v104, s[8:11], 0 offen offset:640
    buffer_load_dwordx4 v[228:231], v104, s[8:11], 0 offen offset:704
    buffer_load_dwordx4 v[232:235], v104, s[8:11], 0 offen offset:768
    buffer_load_dwordx4 v[236:239], v104, s[8:11], 0 offen offset:832
    buffer_load_dwordx4 v[240:243], v104, s[8:11], 0 offen offset:896
    buffer_load_dwordx4 v[244:247], v104, s[8:11], 0 offen offset:960
    buffer_load_dwordx4 v[248:251], v104, s[8:11], 0 offen offset:1024
    buffer_load_dwordx4 v[252:255], v104, s[8:11], 0 offen offset:1088
    s_lshl_b32 s76, s3, 2
    s_add_u32 s76, s76, s5
    s_and_b32 s77, s3, 3
    s_add_u32 s77, s77, 32
    s_lshl_b32 s36, s5, 11
    s_lshl_b32 s78, s5, 7
    s_lshl_b32 s74, s77, 4
    s_add_u32 s74, s74, 0
    v_lshrrev_b32 v106, 3, v11
    v_add_u32 v106, s74, v106
    s_movk_i32 s75, 288
    v_cmp_lt_u32 vcc, s75, v106
    v_subrev_u32 v107, s75, v106
    v_mov_b32 v108, s64
    v_mov_b32 v109, s65
    v_mov_b32 v36, s66
    v_mov_b32 v37, s67
    v_cndmask_b32 v106, v106, v107, vcc
    v_cndmask_b32 v36, v108, v36, vcc
    v_cndmask_b32 v37, v109, v37, vcc
    v_mul_u32_u24 v106, 0x480, v106
    s_lshr_b32 s74, 0, 1
    v_lshrrev_b32 v107, 4, v11
    v_add_u32 v107, s74, v107
    v_and_b32 v108, 7, v11
    v_xor_b32 v107, v107, v108
    v_lshlrev_b32 v107, 4, v107
    v_add_u32 v106, v106, v107
    v_add_u32 v106, s78, v106
    v_add_co_u32 v36, vcc, v36, v106
    s_nop 1
    v_addc_co_u32 v37, vcc, 0, v37, vcc
    s_lshl_b32 s74, s77, 4
    s_add_u32 s74, s74, 8
    v_lshrrev_b32 v106, 3, v11
    v_add_u32 v106, s74, v106
    s_movk_i32 s75, 288
    v_cmp_lt_u32 vcc, s75, v106
    v_subrev_u32 v107, s75, v106
    v_mov_b32 v108, s64
    v_mov_b32 v109, s65
    v_mov_b32 v38, s66
    v_mov_b32 v39, s67
    v_cndmask_b32 v106, v106, v107, vcc
    v_cndmask_b32 v38, v108, v38, vcc
    v_cndmask_b32 v39, v109, v39, vcc
    v_mul_u32_u24 v106, 0x480, v106
    s_lshr_b32 s74, 8, 1
    v_lshrrev_b32 v107, 4, v11
    v_add_u32 v107, s74, v107
    v_and_b32 v108, 7, v11
    v_xor_b32 v107, v107, v108
    v_lshlrev_b32 v107, 4, v107
    v_add_u32 v106, v106, v107
    v_add_u32 v106, s78, v106
    v_add_co_u32 v38, vcc, v38, v106
    s_nop 1
    v_addc_co_u32 v39, vcc, 0, v39, vcc
    v_subrev_co_u32 v38, vcc, 1024, v38
    s_nop 1
    v_subbrev_co_u32 v39, vcc, 0, v39, vcc
    s_add_u32 m0, s36, 57344
    s_nop 0
    global_load_lds_dwordx4 v[36:37], off
    global_load_lds_dwordx4 v[38:39], off offset:1024
    s_add_u32 m0, s36, 65024
    s_nop 0
    global_load_lds_dwordx4 v[36:37], off offset:512
    global_load_lds_dwordx4 v[38:39], off offset:1536
    s_and_b32 s79, s5, 1
    s_lshl_b32 s78, s79, 10
    s_add_u32 m0, s78, 151552
    s_lshl_b32 s79, s79, 3
    s_movk_i32 s78, 1024
    s_lshl_b32 s74, s77, 4
    s_add_u32 s74, s74, s79
    v_lshrrev_b32 v106, 3, v11
    v_add_u32 v106, s74, v106
    s_movk_i32 s75, 288
    v_cmp_lt_u32 vcc, s75, v106
    v_subrev_u32 v107, s75, v106
    v_mov_b32 v108, s64
    v_mov_b32 v109, s65
    v_mov_b32 v40, s66
    v_mov_b32 v41, s67
    v_cndmask_b32 v106, v106, v107, vcc
    v_cndmask_b32 v40, v108, v40, vcc
    v_cndmask_b32 v41, v109, v41, vcc
    v_mul_u32_u24 v106, 0x480, v106
    s_lshr_b32 s74, s79, 1
    v_lshrrev_b32 v107, 4, v11
    v_add_u32 v107, s74, v107
    v_and_b32 v108, 7, v11
    v_xor_b32 v107, v107, v108
    v_lshlrev_b32 v107, 4, v107
    v_add_u32 v106, v106, v107
    v_add_u32 v106, s78, v106
    v_add_co_u32 v40, vcc, v40, v106
    s_nop 1
    v_addc_co_u32 v41, vcc, 0, v41, vcc
    global_load_lds_dwordx4 v[40:41], off
    s_lshl_b32 s74, s76, 4
    s_add_u32 s74, s74, 0
    v_lshrrev_b32 v106, 3, v11
    v_add_u32 v106, s74, v106
    s_movk_i32 s75, 288
    v_cmp_lt_u32 vcc, s75, v106
    v_subrev_u32 v107, s75, v106
    v_mov_b32 v108, s64
    v_mov_b32 v109, s65
    v_mov_b32 v32, s66
    v_mov_b32 v33, s67
    v_cndmask_b32 v106, v106, v107, vcc
    v_cndmask_b32 v32, v108, v32, vcc
    v_cndmask_b32 v33, v109, v33, vcc
    v_mul_u32_u24 v106, 0x480, v106
    s_lshr_b32 s74, 0, 1
    v_lshrrev_b32 v107, 4, v11
    v_add_u32 v107, s74, v107
    v_and_b32 v108, 7, v11
    v_xor_b32 v107, v107, v108
    v_lshlrev_b32 v107, 4, v107
    v_add_u32 v106, v106, v107
    v_add_u32 v106, 0, v106
    v_add_co_u32 v32, vcc, v32, v106
    s_nop 1
    v_addc_co_u32 v33, vcc, 0, v33, vcc
    s_lshl_b32 s74, s76, 4
    s_add_u32 s74, s74, 8
    v_lshrrev_b32 v106, 3, v11
    v_add_u32 v106, s74, v106
    s_movk_i32 s75, 288
    v_cmp_lt_u32 vcc, s75, v106
    v_subrev_u32 v107, s75, v106
    v_mov_b32 v108, s64
    v_mov_b32 v109, s65
    v_mov_b32 v34, s66
    v_mov_b32 v35, s67
    v_cndmask_b32 v106, v106, v107, vcc
    v_cndmask_b32 v34, v108, v34, vcc
    v_cndmask_b32 v35, v109, v35, vcc
    v_mul_u32_u24 v106, 0x480, v106
    s_lshr_b32 s74, 8, 1
    v_lshrrev_b32 v107, 4, v11
    v_add_u32 v107, s74, v107
    v_and_b32 v108, 7, v11
    v_xor_b32 v107, v107, v108
    v_lshlrev_b32 v107, 4, v107
    v_add_u32 v106, v106, v107
    v_add_u32 v106, 0, v106
    v_add_co_u32 v34, vcc, v34, v106
    s_nop 1
    v_addc_co_u32 v35, vcc, 0, v35, vcc
    v_subrev_co_u32 v34, vcc, 1024, v34
    s_nop 1
    v_subbrev_co_u32 v35, vcc, 0, v35, vcc
    s_add_u32 m0, s36, 0
    s_nop 0
    global_load_lds_dwordx4 v[32:33], off offset:0
    global_load_lds_dwordx4 v[34:35], off offset:1024
    s_add_u32 m0, s36, 8064
    s_nop 0
    global_load_lds_dwordx4 v[32:33], off offset:128
    global_load_lds_dwordx4 v[34:35], off offset:1152
    s_add_u32 m0, s36, 16128
    s_nop 0
    global_load_lds_dwordx4 v[32:33], off offset:256
    global_load_lds_dwordx4 v[34:35], off offset:1280
    s_mov_b32 s12, s68
    s_mov_b32 s13, s69
    s_mov_b32 s14, 5308416
    s_mov_b32 s15, 0x00020000
    s_sub_u32 s16, s70, 1024
    s_subb_u32 s17, s71, 0
    s_mov_b32 s18, 5309440
    s_mov_b32 s19, 0x00020000
    s_mov_b32 s20, s72
    s_mov_b32 s21, s73
    s_mov_b32 s22, 268435456
    s_mov_b32 s23, 0x00020000
    s_mov_b32 s40, 0
    s_mov_b32 s41, 294912
    s_mov_b32 s42, 589824
    s_mov_b32 s43, 884736
    s_mov_b32 s44, 1179648
    s_mov_b32 s45, 1474560
    s_mov_b32 s46, 1769472
    s_mov_b32 s47, 2064384
    s_mov_b32 s48, 2359296
    s_mov_b32 s49, 2654208
    s_mov_b32 s50, 2949120
    s_mov_b32 s51, 3244032
    s_mov_b32 s52, 3538944
    s_mov_b32 s53, 3833856
    s_mov_b32 s54, 4128768
    s_mov_b32 s55, 4423680
    s_mov_b32 s56, 4718592
    s_mov_b32 s57, 5013504
    s_mov_b32 s39, 0x3fb8aa3b
    v_lshrrev_b32 v104, 3, v11
    v_and_b32 v105, 7, v11
    s_lshl_b32 s74, s5, 3
    v_add_u32 v106, s74, v104
    v_bfe_u32 v107, v11, 4, 1
    s_and_b32 s75, s5, 1
    s_lshl_b32 s75, s75, 1
    v_add_u32 v107, s75, v107
    v_lshlrev_b32 v107, 1, v107
    v_xor_b32 v107, v105, v107
    v_lshlrev_b32 v107, 4, v107
    s_movk_i32 s74, 0x2400
    v_mul_lo_u32 v1, v106, s74
    v_add_u32 v1, v1, v107
    s_mul_i32 s74, s3, 1152
    v_add_u32 v1, s74, v1
    v_and_b32 v106, 3, v104
    v_lshrrev_b32 v104, 2, v104
    v_lshlrev_b32 v104, 4, v104
    v_add_u32 v106, v106, v104
    s_lshl_b32 s74, s5, 2
    s_mul_i32 s75, s3, 576
    s_add_u32 s74, s74, s75
    v_add_u32 v106, s74, v106
    v_mul_u32_u24 v106, 0x480, v106
    v_add_u32 v10, v106, v107
    v_bfe_u32 v104, v11, 2, 2
    v_and_b32 v105, 3, v11
    v_lshrrev_b32 v106, 1, v105
    s_lshl_b32 s74, s5, 1
    v_add_u32 v106, s74, v106
    v_and_b32 v105, 1, v105
    v_lshlrev_b32 v105, 3, v105
    v_lshrrev_b32 v107, 1, v104
    v_and_b32 v108, 1, v14
    v_lshlrev_b32 v109, 1, v108
    v_add_u32 v107, v107, v109
    v_lshlrev_b32 v107, 1, v107
    v_xor_b32 v107, v106, v107
    v_lshlrev_b32 v107, 4, v107
    v_lshlrev_b32 v2, 11, v14
    v_lshlrev_b32 v109, 7, v104
    v_add_u32 v2, v2, v109
    v_add_u32 v2, v2, v107
    v_add_u32 v2, v2, v105
    v_add_u32 v3, 0x10000, v2
    v_lshlrev_b32 v7, 4, v11
    v_add_u32 v7, 73728, v7
    v_add_u32 v8, 0x10000, v7
    v_lshrrev_b32 v104, 1, v13
    v_xor_b32 v104, v14, v104
    v_lshlrev_b32 v105, 3, v13
    v_or_b32 v104, v104, v105
    v_lshlrev_b32 v46, 4, v104
    v_add_u32 v42, s36, v46
    v_xor_b32 v43, 64, v42
    v_add_u32 v44, 0x10000, v42
    v_add_u32 v45, 0x10000, v43
    v_xor_b32 v47, 64, v46
    v_add_u32 v48, 151552, v46
    v_add_u32 v49, 151552, v47
    v_add_u32 v46, 57344, v46
    v_add_u32 v47, 57344, v47
    s_and_b32 s74, s5, 1
    s_lshl_b32 s74, s74, 3
    s_lshr_b32 s75, s5, 1
    s_lshl_b32 s75, s75, 12
    s_add_u32 s74, s74, s75
    v_add_u32 v6, s74, v7
    v_lshlrev_b32 v9, 9, v108
    v_and_b32 v104, 1, v13
    v_lshlrev_b32 v104, 8, v104
    v_add_u32 v9, v9, v104
    v_lshrrev_b32 v104, 1, v13
    v_lshlrev_b32 v104, 5, v104
    v_add_u32 v9, v9, v104
    v_lshrrev_b32 v104, 1, v14
    v_lshlrev_b32 v104, 4, v104
    v_add_u32 v9, v9, v104
    s_mul_i32 s58, s3, 2359296
    s_lshl_b32 s74, s5, 16
    s_add_u32 s58, s58, s74
    s_lshl_b32 s74, s4, 11
    s_add_u32 s58, s58, s74
    s_add_u32 s58, s58, 2097152
    s_and_b32 s74, s4, 1
    s_lshl_b32 s74, s74, 9
    v_lshrrev_b32 v104, 1, v14
    v_lshlrev_b32 v104, 8, v104
    v_lshlrev_b32 v105, 4, v13
    v_add_u32 v104, v104, v105
    v_lshlrev_b32 v105, 3, v108
    v_add_u32 v104, v104, v105
    v_add_u32 v12, s74, v104
    s_add_u32 m0, s36, 24192
    s_nop 0
    global_load_lds_dwordx4 v[32:33], off offset:384
    global_load_lds_dwordx4 v[34:35], off offset:1408
    s_add_u32 m0, s36, 32256
    s_nop 0
    global_load_lds_dwordx4 v[32:33], off offset:512
    global_load_lds_dwordx4 v[34:35], off offset:1536
    s_add_u32 m0, s36, 40320
    s_nop 0
    global_load_lds_dwordx4 v[32:33], off offset:640
    global_load_lds_dwordx4 v[34:35], off offset:1664
    s_add_u32 m0, s36, 48384
    s_nop 0
    global_load_lds_dwordx4 v[32:33], off offset:768
    global_load_lds_dwordx4 v[34:35], off offset:1792
    s_lshl_b32 s74, s4, 2
    s_add_u32 s74, s74, s5
    s_add_u32 s75, s74, 0
    s_cmp_ge_u32 s75, 81
    s_cselect_b32 s78, 1, 0
    s_cmp_ge_u32 s75, 162
    s_addc_u32 s78, s78, 0
    s_mul_i32 s79, s78, 81
    s_sub_u32 s79, s75, s79
    s_lshl_b32 s79, s79, 6
    v_add_u32 v104, s79, v11
    v_mul_u32_u24 v105, 7282, v104
    v_lshrrev_b32 v105, 16, v105
    v_mul_u32_u24 v106, 9, v105
    v_sub_u32 v106, v104, v106
    v_lshlrev_b32 v106, 7, v106
    s_cmp_eq_u32 s78, 2
    s_movk_i32 s79, 1152
    s_cselect_b32 s79, s79, 9216
    s_cselect_b32 s28, s24, s68
    s_cselect_b32 s29, s25, s69
    s_mul_i32 s32, s3, 1152
    s_mul_i32 s33, s3, 663552
    s_cselect_b32 s32, s33, s32
    s_cmp_eq_u32 s78, 1
    s_cselect_b32 s28, s70, s28
    s_cselect_b32 s29, s71, s29
    s_cmp_ge_u32 s75, 243
    s_cselect_b32 s30, 0, 5308416
    s_mov_b32 s31, 0x00020000
    v_mul_lo_u32 v105, v105, s79
    v_add_u32 v105, v105, v106
    buffer_load_dword v4, v105, s[28:31], s32 offen offset:0
    s_add_u32 s75, s74, 128
    s_cmp_ge_u32 s75, 81
    s_cselect_b32 s78, 1, 0
    s_cmp_ge_u32 s75, 162
    s_addc_u32 s78, s78, 0
    s_mul_i32 s79, s78, 81
    s_sub_u32 s79, s75, s79
    s_lshl_b32 s79, s79, 6
    v_add_u32 v104, s79, v11
    v_mul_u32_u24 v105, 7282, v104
    v_lshrrev_b32 v105, 16, v105
    v_mul_u32_u24 v106, 9, v105
    v_sub_u32 v106, v104, v106
    v_lshlrev_b32 v106, 7, v106
    s_cmp_eq_u32 s78, 2
    s_movk_i32 s79, 1152
    s_cselect_b32 s79, s79, 9216
    s_cselect_b32 s28, s24, s68
    s_cselect_b32 s29, s25, s69
    s_mul_i32 s32, s3, 1152
    s_mul_i32 s33, s3, 663552
    s_cselect_b32 s32, s33, s32
    s_cmp_eq_u32 s78, 1
    s_cselect_b32 s28, s70, s28
    s_cselect_b32 s29, s71, s29
    s_cmp_ge_u32 s75, 243
    s_cselect_b32 s30, 0, 5308416
    s_mov_b32 s31, 0x00020000
    v_mul_lo_u32 v105, v105, s79
    v_add_u32 v105, v105, v106
    buffer_load_dword v4, v105, s[28:31], s32 offen offset:0
    s_mov_b32 s60, 0x3f803f80
    s_mov_b32 s61, 0x00003f80
    s_mov_b32 s62, 0x3f800000
    s_waitcnt vmcnt(38)
    v_dot2_f32_bf16 v104, v184, s60, 0
    v_dot2_f32_bf16 v105, v185, s60, 0
    v_dot2_f32_bf16 v106, v186, s60, 0
    v_dot2_f32_bf16 v107, v187, s60, 0
    s_waitcnt vmcnt(37)
    v_dot2_f32_bf16 v104, v188, s60, v104
    v_dot2_f32_bf16 v105, v189, s60, v105
    v_dot2_f32_bf16 v106, v190, s60, v106
    v_dot2_f32_bf16 v107, v191, s60, v107
    s_waitcnt vmcnt(36)
    v_dot2_f32_bf16 v104, v192, s60, v104
    v_dot2_f32_bf16 v105, v193, s60, v105
    v_dot2_f32_bf16 v106, v194, s60, v106
    v_dot2_f32_bf16 v107, v195, s60, v107
    s_waitcnt vmcnt(35)
    v_dot2_f32_bf16 v104, v196, s60, v104
    v_dot2_f32_bf16 v105, v197, s60, v105
    v_dot2_f32_bf16 v106, v198, s60, v106
    v_dot2_f32_bf16 v107, v199, s60, v107
    s_waitcnt vmcnt(34)
    v_dot2_f32_bf16 v104, v200, s60, v104
    v_dot2_f32_bf16 v105, v201, s60, v105
    v_dot2_f32_bf16 v106, v202, s60, v106
    v_dot2_f32_bf16 v107, v203, s60, v107
    s_waitcnt vmcnt(33)
    v_dot2_f32_bf16 v104, v204, s60, v104
    v_dot2_f32_bf16 v105, v205, s60, v105
    v_dot2_f32_bf16 v106, v206, s60, v106
    v_dot2_f32_bf16 v107, v207, s60, v107
    s_waitcnt vmcnt(32)
    v_dot2_f32_bf16 v104, v208, s60, v104
    v_dot2_f32_bf16 v105, v209, s60, v105
    v_dot2_f32_bf16 v106, v210, s60, v106
    v_dot2_f32_bf16 v107, v211, s60, v107
    s_waitcnt vmcnt(31)
    v_dot2_f32_bf16 v104, v212, s60, v104
    v_dot2_f32_bf16 v105, v213, s60, v105
    v_dot2_f32_bf16 v106, v214, s60, v106
    v_dot2_f32_bf16 v107, v215, s60, v107
    s_waitcnt vmcnt(30)
    v_dot2_f32_bf16 v104, v216, s60, v104
    v_dot2_f32_bf16 v105, v217, s60, v105
    v_dot2_f32_bf16 v106, v218, s60, v106
    v_dot2_f32_bf16 v107, v219, s60, v107
    s_waitcnt vmcnt(29)
    v_dot2_f32_bf16 v104, v220, s60, v104
    v_dot2_f32_bf16 v105, v221, s60, v105
    v_dot2_f32_bf16 v106, v222, s60, v106
    v_dot2_f32_bf16 v107, v223, s60, v107
    s_waitcnt vmcnt(28)
    v_dot2_f32_bf16 v104, v224, s60, v104
    v_dot2_f32_bf16 v105, v225, s60, v105
    v_dot2_f32_bf16 v106, v226, s60, v106
    v_dot2_f32_bf16 v107, v227, s60, v107
    s_waitcnt vmcnt(27)
    v_dot2_f32_bf16 v104, v228, s60, v104
    v_dot2_f32_bf16 v105, v229, s60, v105
    v_dot2_f32_bf16 v106, v230, s60, v106
    v_dot2_f32_bf16 v107, v231, s60, v107
    s_waitcnt vmcnt(26)
    v_dot2_f32_bf16 v104, v232, s60, v104
    v_dot2_f32_bf16 v105, v233, s60, v105
    v_dot2_f32_bf16 v106, v234, s60, v106
    v_dot2_f32_bf16 v107, v235, s60, v107
    s_waitcnt vmcnt(25)
    v_dot2_f32_bf16 v104, v236, s60, v104
    v_dot2_f32_bf16 v105, v237, s60, v105
    v_dot2_f32_bf16 v106, v238, s60, v106
    v_dot2_f32_bf16 v107, v239, s60, v107
    s_waitcnt vmcnt(24)
    v_dot2_f32_bf16 v104, v240, s60, v104
    v_dot2_f32_bf16 v105, v241, s60, v105
    v_dot2_f32_bf16 v106, v242, s60, v106
    v_dot2_f32_bf16 v107, v243, s60, v107
    s_waitcnt vmcnt(23)
    v_dot2_f32_bf16 v104, v244, s60, v104
    v_dot2_f32_bf16 v105, v245, s60, v105
    v_dot2_f32_bf16 v106, v246, s60, v106
    v_dot2_f32_bf16 v107, v247, s60, v107
    s_waitcnt vmcnt(22)
    v_dot2_f32_bf16 v104, v248, s60, v104
    v_dot2_f32_bf16 v105, v249, s60, v105
    v_dot2_f32_bf16 v106, v250, s60, v106
    v_dot2_f32_bf16 v107, v251, s60, v107
    s_waitcnt vmcnt(21)
    v_dot2_f32_bf16 v104, v252, s60, v104
    v_dot2_f32_bf16 v105, v253, s60, v105
    v_dot2_f32_bf16 v106, v254, s60, v106
    v_dot2_f32_bf16 v107, v255, s60, v107
    s_nop 2
    v_add_f32 v104, v104, v105
    v_add_f32 v106, v106, v107
    v_add_f32 v104, v104, v106
    v_mov_b32 v105, v104
    s_nop 1
    v_permlane32_swap_b32 v104, v105
    v_add_f32 v104, v104, v105
    v_mov_b32 v105, v104
    s_nop 1
    v_permlane16_swap_b32 v104, v105
    v_add_f32 v104, v104, v105
    v_mul_f32 v108, 0xbae38e39, v104
    v_dot2_f32_bf16 v112, v184, s61, v108
    v_dot2_f32_bf16 v113, v184, s62, v108
    v_dot2_f32_bf16 v114, v185, s61, v108
    v_dot2_f32_bf16 v115, v185, s62, v108
    v_dot2_f32_bf16 v116, v186, s61, v108
    v_dot2_f32_bf16 v117, v186, s62, v108
    v_dot2_f32_bf16 v118, v187, s61, v108
    v_dot2_f32_bf16 v119, v187, s62, v108
    v_dot2_f32_bf16 v120, v188, s61, v108
    v_dot2_f32_bf16 v121, v188, s62, v108
    v_dot2_f32_bf16 v122, v189, s61, v108
    v_dot2_f32_bf16 v123, v189, s62, v108
    v_dot2_f32_bf16 v124, v190, s61, v108
    v_dot2_f32_bf16 v125, v190, s62, v108
    v_dot2_f32_bf16 v126, v191, s61, v108
    v_dot2_f32_bf16 v127, v191, s62, v108
    v_dot2_f32_bf16 v128, v192, s61, v108
    v_dot2_f32_bf16 v129, v192, s62, v108
    v_dot2_f32_bf16 v130, v193, s61, v108
    v_dot2_f32_bf16 v131, v193, s62, v108
    v_dot2_f32_bf16 v132, v194, s61, v108
    v_dot2_f32_bf16 v133, v194, s62, v108
    v_dot2_f32_bf16 v134, v195, s61, v108
    v_dot2_f32_bf16 v135, v195, s62, v108
    v_dot2_f32_bf16 v136, v196, s61, v108
    v_dot2_f32_bf16 v137, v196, s62, v108
    v_dot2_f32_bf16 v138, v197, s61, v108
    v_dot2_f32_bf16 v139, v197, s62, v108
    v_dot2_f32_bf16 v140, v198, s61, v108
    v_dot2_f32_bf16 v141, v198, s62, v108
    v_dot2_f32_bf16 v142, v199, s61, v108
    v_dot2_f32_bf16 v143, v199, s62, v108
    v_dot2_f32_bf16 v144, v200, s61, v108
    v_dot2_f32_bf16 v145, v200, s62, v108
    v_dot2_f32_bf16 v146, v201, s61, v108
    v_dot2_f32_bf16 v147, v201, s62, v108
    v_dot2_f32_bf16 v148, v202, s61, v108
    v_dot2_f32_bf16 v149, v202, s62, v108
    v_dot2_f32_bf16 v150, v203, s61, v108
    v_dot2_f32_bf16 v151, v203, s62, v108
    v_dot2_f32_bf16 v152, v204, s61, v108
    v_dot2_f32_bf16 v153, v204, s62, v108
    v_dot2_f32_bf16 v154, v205, s61, v108
    v_dot2_f32_bf16 v155, v205, s62, v108
    v_dot2_f32_bf16 v156, v206, s61, v108
    v_dot2_f32_bf16 v157, v206, s62, v108
    v_dot2_f32_bf16 v158, v207, s61, v108
    v_dot2_f32_bf16 v159, v207, s62, v108
    v_dot2_f32_bf16 v160, v208, s61, v108
    v_dot2_f32_bf16 v161, v208, s62, v108
    v_dot2_f32_bf16 v162, v209, s61, v108
    v_dot2_f32_bf16 v163, v209, s62, v108
    v_dot2_f32_bf16 v164, v210, s61, v108
    v_dot2_f32_bf16 v165, v210, s62, v108
    v_dot2_f32_bf16 v166, v211, s61, v108
    v_dot2_f32_bf16 v167, v211, s62, v108
    v_dot2_f32_bf16 v168, v212, s61, v108
    v_dot2_f32_bf16 v169, v212, s62, v108
    v_dot2_f32_bf16 v170, v213, s61, v108
    v_dot2_f32_bf16 v171, v213, s62, v108
    v_dot2_f32_bf16 v172, v214, s61, v108
    v_dot2_f32_bf16 v173, v214, s62, v108
    v_dot2_f32_bf16 v174, v215, s61, v108
    v_dot2_f32_bf16 v175, v215, s62, v108
    v_dot2_f32_bf16 v176, v216, s61, v108
    v_dot2_f32_bf16 v177, v216, s62, v108
    v_dot2_f32_bf16 v178, v217, s61, v108
    v_dot2_f32_bf16 v179, v217, s62, v108
    v_dot2_f32_bf16 v180, v218, s61, v108
    v_dot2_f32_bf16 v181, v218, s62, v108
    v_dot2_f32_bf16 v182, v219, s61, v108
    v_dot2_f32_bf16 v183, v219, s62, v108
    v_dot2_f32_bf16 v184, v220, s61, v108
    v_dot2_f32_bf16 v185, v220, s62, v108
    v_dot2_f32_bf16 v186, v221, s61, v108
    v_dot2_f32_bf16 v187, v221, s62, v108
    v_dot2_f32_bf16 v188, v222, s61, v108
    v_dot2_f32_bf16 v189, v222, s62, v108
    v_dot2_f32_bf16 v190, v223, s61, v108
    v_dot2_f32_bf16 v191, v223, s62, v108
    v_dot2_f32_bf16 v192, v224, s61, v108
    v_dot2_f32_bf16 v193, v224, s62, v108
    v_dot2_f32_bf16 v194, v225, s61, v108
    v_dot2_f32_bf16 v195, v225, s62, v108
    v_dot2_f32_bf16 v196, v226, s61, v108
    v_dot2_f32_bf16 v197, v226, s62, v108
    v_dot2_f32_bf16 v198, v227, s61, v108
    v_dot2_f32_bf16 v199, v227, s62, v108
    v_dot2_f32_bf16 v200, v228, s61, v108
    v_dot2_f32_bf16 v201, v228, s62, v108
    v_dot2_f32_bf16 v202, v229, s61, v108
    v_dot2_f32_bf16 v203, v229, s62, v108
    v_dot2_f32_bf16 v204, v230, s61, v108
    v_dot2_f32_bf16 v205, v230, s62, v108
    v_dot2_f32_bf16 v206, v231, s61, v108
    v_dot2_f32_bf16 v207, v231, s62, v108
    v_dot2_f32_bf16 v208, v232, s61, v108
    v_dot2_f32_bf16 v209, v232, s62, v108
    v_dot2_f32_bf16 v210, v233, s61, v108
    v_dot2_f32_bf16 v211, v233, s62, v108
    v_dot2_f32_bf16 v212, v234, s61, v108
    v_dot2_f32_bf16 v213, v234, s62, v108
    v_dot2_f32_bf16 v214, v235, s61, v108
    v_dot2_f32_bf16 v215, v235, s62, v108
    v_dot2_f32_bf16 v216, v236, s61, v108
    v_dot2_f32_bf16 v217, v236, s62, v108
    v_dot2_f32_bf16 v218, v237, s61, v108
    v_dot2_f32_bf16 v219, v237, s62, v108
    v_dot2_f32_bf16 v220, v238, s61, v108
    v_dot2_f32_bf16 v221, v238, s62, v108
    v_dot2_f32_bf16 v222, v239, s61, v108
    v_dot2_f32_bf16 v223, v239, s62, v108
    v_dot2_f32_bf16 v224, v240, s61, v108
    v_dot2_f32_bf16 v225, v240, s62, v108
    v_dot2_f32_bf16 v226, v241, s61, v108
    v_dot2_f32_bf16 v227, v241, s62, v108
    v_dot2_f32_bf16 v228, v242, s61, v108
    v_dot2_f32_bf16 v229, v242, s62, v108
    v_dot2_f32_bf16 v230, v243, s61, v108
    v_dot2_f32_bf16 v231, v243, s62, v108
    v_dot2_f32_bf16 v232, v244, s61, v108
    v_dot2_f32_bf16 v233, v244, s62, v108
    v_dot2_f32_bf16 v234, v245, s61, v108
    v_dot2_f32_bf16 v235, v245, s62, v108
    v_dot2_f32_bf16 v236, v246, s61, v108
    v_dot2_f32_bf16 v237, v246, s62, v108
    v_dot2_f32_bf16 v238, v247, s61, v108
    v_dot2_f32_bf16 v239, v247, s62, v108
    v_dot2_f32_bf16 v240, v248, s61, v108
    v_dot2_f32_bf16 v241, v248, s62, v108
    v_dot2_f32_bf16 v242, v249, s61, v108
    v_dot2_f32_bf16 v243, v249, s62, v108
    v_dot2_f32_bf16 v244, v250, s61, v108
    v_dot2_f32_bf16 v245, v250, s62, v108
    v_dot2_f32_bf16 v246, v251, s61, v108
    v_dot2_f32_bf16 v247, v251, s62, v108
    v_dot2_f32_bf16 v248, v252, s61, v108
    v_dot2_f32_bf16 v249, v252, s62, v108
    v_dot2_f32_bf16 v250, v253, s61, v108
    v_dot2_f32_bf16 v251, v253, s62, v108
    v_dot2_f32_bf16 v252, v254, s61, v108
    v_dot2_f32_bf16 v253, v254, s62, v108
    v_dot2_f32_bf16 v254, v255, s61, v108
    v_dot2_f32_bf16 v255, v255, s62, v108
    v_pk_mul_f32 v[104:105], v[112:113], v[112:113]
    v_pk_mul_f32 v[106:107], v[114:115], v[114:115]
    v_pk_fma_f32 v[104:105], v[116:117], v[116:117], v[104:105]
    v_pk_fma_f32 v[106:107], v[118:119], v[118:119], v[106:107]
    v_pk_fma_f32 v[104:105], v[120:121], v[120:121], v[104:105]
    v_pk_fma_f32 v[106:107], v[122:123], v[122:123], v[106:107]
    v_pk_fma_f32 v[104:105], v[124:125], v[124:125], v[104:105]
    v_pk_fma_f32 v[106:107], v[126:127], v[126:127], v[106:107]
    v_pk_fma_f32 v[104:105], v[128:129], v[128:129], v[104:105]
    v_pk_fma_f32 v[106:107], v[130:131], v[130:131], v[106:107]
    v_pk_fma_f32 v[104:105], v[132:133], v[132:133], v[104:105]
    v_pk_fma_f32 v[106:107], v[134:135], v[134:135], v[106:107]
    v_pk_fma_f32 v[104:105], v[136:137], v[136:137], v[104:105]
    v_pk_fma_f32 v[106:107], v[138:139], v[138:139], v[106:107]
    v_pk_fma_f32 v[104:105], v[140:141], v[140:141], v[104:105]
    v_pk_fma_f32 v[106:107], v[142:143], v[142:143], v[106:107]
    v_pk_fma_f32 v[104:105], v[144:145], v[144:145], v[104:105]
    v_pk_fma_f32 v[106:107], v[146:147], v[146:147], v[106:107]
    v_pk_fma_f32 v[104:105], v[148:149], v[148:149], v[104:105]
    v_pk_fma_f32 v[106:107], v[150:151], v[150:151], v[106:107]
    v_pk_fma_f32 v[104:105], v[152:153], v[152:153], v[104:105]
    v_pk_fma_f32 v[106:107], v[154:155], v[154:155], v[106:107]
    v_pk_fma_f32 v[104:105], v[156:157], v[156:157], v[104:105]
    v_pk_fma_f32 v[106:107], v[158:159], v[158:159], v[106:107]
    v_pk_fma_f32 v[104:105], v[160:161], v[160:161], v[104:105]
    v_pk_fma_f32 v[106:107], v[162:163], v[162:163], v[106:107]
    v_pk_fma_f32 v[104:105], v[164:165], v[164:165], v[104:105]
    v_pk_fma_f32 v[106:107], v[166:167], v[166:167], v[106:107]
    v_pk_fma_f32 v[104:105], v[168:169], v[168:169], v[104:105]
    v_pk_fma_f32 v[106:107], v[170:171], v[170:171], v[106:107]
    v_pk_fma_f32 v[104:105], v[172:173], v[172:173], v[104:105]
    v_pk_fma_f32 v[106:107], v[174:175], v[174:175], v[106:107]
    v_pk_fma_f32 v[104:105], v[176:177], v[176:177], v[104:105]
    v_pk_fma_f32 v[106:107], v[178:179], v[178:179], v[106:107]
    v_pk_fma_f32 v[104:105], v[180:181], v[180:181], v[104:105]
    v_pk_fma_f32 v[106:107], v[182:183], v[182:183], v[106:107]
    v_pk_fma_f32 v[104:105], v[184:185], v[184:185], v[104:105]
    v_pk_fma_f32 v[106:107], v[186:187], v[186:187], v[106:107]
    v_pk_fma_f32 v[104:105], v[188:189], v[188:189], v[104:105]
    v_pk_fma_f32 v[106:107], v[190:191], v[190:191], v[106:107]
    v_pk_fma_f32 v[104:105], v[192:193], v[192:193], v[104:105]
    v_pk_fma_f32 v[106:107], v[194:195], v[194:195], v[106:107]
    v_pk_fma_f32 v[104:105], v[196:197], v[196:197], v[104:105]
    v_pk_fma_f32 v[106:107], v[198:199], v[198:199], v[106:107]
    v_pk_fma_f32 v[104:105], v[200:201], v[200:201], v[104:105]
    v_pk_fma_f32 v[106:107], v[202:203], v[202:203], v[106:107]
    v_pk_fma_f32 v[104:105], v[204:205], v[204:205], v[104:105]
    v_pk_fma_f32 v[106:107], v[206:207], v[206:207], v[106:107]
    v_pk_fma_f32 v[104:105], v[208:209], v[208:209], v[104:105]
    v_pk_fma_f32 v[106:107], v[210:211], v[210:211], v[106:107]
    v_pk_fma_f32 v[104:105], v[212:213], v[212:213], v[104:105]
    v_pk_fma_f32 v[106:107], v[214:215], v[214:215], v[106:107]
    v_pk_fma_f32 v[104:105], v[216:217], v[216:217], v[104:105]
    v_pk_fma_f32 v[106:107], v[218:219], v[218:219], v[106:107]
    v_pk_fma_f32 v[104:105], v[220:221], v[220:221], v[104:105]
    v_pk_fma_f32 v[106:107], v[222:223], v[222:223], v[106:107]
    v_pk_fma_f32 v[104:105], v[224:225], v[224:225], v[104:105]
    v_pk_fma_f32 v[106:107], v[226:227], v[226:227], v[106:107]
    v_pk_fma_f32 v[104:105], v[228:229], v[228:229], v[104:105]
    v_pk_fma_f32 v[106:107], v[230:231], v[230:231], v[106:107]
    v_pk_fma_f32 v[104:105], v[232:233], v[232:233], v[104:105]
    v_pk_fma_f32 v[106:107], v[234:235], v[234:235], v[106:107]
    v_pk_fma_f32 v[104:105], v[236:237], v[236:237], v[104:105]
    v_pk_fma_f32 v[106:107], v[238:239], v[238:239], v[106:107]
    v_pk_fma_f32 v[104:105], v[240:241], v[240:241], v[104:105]
    v_pk_fma_f32 v[106:107], v[242:243], v[242:243], v[106:107]
    v_pk_fma_f32 v[104:105], v[244:245], v[244:245], v[104:105]
    v_pk_fma_f32 v[106:107], v[246:247], v[246:247], v[106:107]
    v_pk_fma_f32 v[104:105], v[248:249], v[248:249], v[104:105]
    v_pk_fma_f32 v[106:107], v[250:251], v[250:251], v[106:107]
    v_pk_fma_f32 v[104:105], v[252:253], v[252:253], v[104:105]
    v_pk_fma_f32 v[106:107], v[254:255], v[254:255], v[106:107]
    v_add_f32 v104, v104, v105
    v_add_f32 v106, v106, v107
    v_add_f32 v104, v104, v106
    v_mov_b32 v105, v104
    s_nop 1
    v_permlane32_swap_b32 v104, v105
    v_add_f32 v104, v104, v105
    v_mov_b32 v105, v104
    s_nop 1
    v_permlane16_swap_b32 v104, v105
    v_add_f32 v104, v104, v105
    s_mov_b32 s63, 0x3727c5ac
    s_mov_b32 s74, 0x3ae38e39
    v_mov_b32 v105, s63
    v_fma_f32 v104, v104, s74, v105
    v_rsq_f32 v104, v104
    s_nop 0
    v_mul_f32 v108, 0x3fb8aa3b, v104
    s_lshl_b32 s74, s5, 10
    v_add_u32 v110, s74, v7
    v_add_u32 v111, 0x10000, v110
    v_pk_mul_f32 v[112:113], v[112:113], v[108:109] op_sel_hi:[1,0]
    v_pk_mul_f32 v[114:115], v[114:115], v[108:109] op_sel_hi:[1,0]
    v_pk_mul_f32 v[116:117], v[116:117], v[108:109] op_sel_hi:[1,0]
    v_pk_mul_f32 v[118:119], v[118:119], v[108:109] op_sel_hi:[1,0]
    v_cvt_pk_bf16_f32 v112, v112, v113
    v_cvt_pk_bf16_f32 v113, v114, v115
    v_cvt_pk_bf16_f32 v114, v116, v117
    v_cvt_pk_bf16_f32 v115, v118, v119
    ds_write_b128 v110, v[112:115] offset:0
    v_pk_mul_f32 v[120:121], v[120:121], v[108:109] op_sel_hi:[1,0]
    v_pk_mul_f32 v[122:123], v[122:123], v[108:109] op_sel_hi:[1,0]
    v_pk_mul_f32 v[124:125], v[124:125], v[108:109] op_sel_hi:[1,0]
    v_pk_mul_f32 v[126:127], v[126:127], v[108:109] op_sel_hi:[1,0]
    v_cvt_pk_bf16_f32 v116, v120, v121
    v_cvt_pk_bf16_f32 v117, v122, v123
    v_cvt_pk_bf16_f32 v118, v124, v125
    v_cvt_pk_bf16_f32 v119, v126, v127
    ds_write_b128 v110, v[116:119] offset:4096
    v_pk_mul_f32 v[128:129], v[128:129], v[108:109] op_sel_hi:[1,0]
    v_pk_mul_f32 v[130:131], v[130:131], v[108:109] op_sel_hi:[1,0]
    v_pk_mul_f32 v[132:133], v[132:133], v[108:109] op_sel_hi:[1,0]
    v_pk_mul_f32 v[134:135], v[134:135], v[108:109] op_sel_hi:[1,0]
    v_cvt_pk_bf16_f32 v120, v128, v129
    v_cvt_pk_bf16_f32 v121, v130, v131
    v_cvt_pk_bf16_f32 v122, v132, v133
    v_cvt_pk_bf16_f32 v123, v134, v135
    ds_write_b128 v110, v[120:123] offset:8192
    v_pk_mul_f32 v[136:137], v[136:137], v[108:109] op_sel_hi:[1,0]
    v_pk_mul_f32 v[138:139], v[138:139], v[108:109] op_sel_hi:[1,0]
    v_pk_mul_f32 v[140:141], v[140:141], v[108:109] op_sel_hi:[1,0]
    v_pk_mul_f32 v[142:143], v[142:143], v[108:109] op_sel_hi:[1,0]
    v_cvt_pk_bf16_f32 v124, v136, v137
    v_cvt_pk_bf16_f32 v125, v138, v139
    v_cvt_pk_bf16_f32 v126, v140, v141
    v_cvt_pk_bf16_f32 v127, v142, v143
    ds_write_b128 v110, v[124:127] offset:12288
    v_pk_mul_f32 v[144:145], v[144:145], v[108:109] op_sel_hi:[1,0]
    v_pk_mul_f32 v[146:147], v[146:147], v[108:109] op_sel_hi:[1,0]
    v_pk_mul_f32 v[148:149], v[148:149], v[108:109] op_sel_hi:[1,0]
    v_pk_mul_f32 v[150:151], v[150:151], v[108:109] op_sel_hi:[1,0]
    v_cvt_pk_bf16_f32 v128, v144, v145
    v_cvt_pk_bf16_f32 v129, v146, v147
    v_cvt_pk_bf16_f32 v130, v148, v149
    v_cvt_pk_bf16_f32 v131, v150, v151
    ds_write_b128 v110, v[128:131] offset:16384
    v_pk_mul_f32 v[152:153], v[152:153], v[108:109] op_sel_hi:[1,0]
    v_pk_mul_f32 v[154:155], v[154:155], v[108:109] op_sel_hi:[1,0]
    v_pk_mul_f32 v[156:157], v[156:157], v[108:109] op_sel_hi:[1,0]
    v_pk_mul_f32 v[158:159], v[158:159], v[108:109] op_sel_hi:[1,0]
    v_cvt_pk_bf16_f32 v132, v152, v153
    v_cvt_pk_bf16_f32 v133, v154, v155
    v_cvt_pk_bf16_f32 v134, v156, v157
    v_cvt_pk_bf16_f32 v135, v158, v159
    ds_write_b128 v110, v[132:135] offset:20480
    v_pk_mul_f32 v[160:161], v[160:161], v[108:109] op_sel_hi:[1,0]
    v_pk_mul_f32 v[162:163], v[162:163], v[108:109] op_sel_hi:[1,0]
    v_pk_mul_f32 v[164:165], v[164:165], v[108:109] op_sel_hi:[1,0]
    v_pk_mul_f32 v[166:167], v[166:167], v[108:109] op_sel_hi:[1,0]
    v_cvt_pk_bf16_f32 v136, v160, v161
    v_cvt_pk_bf16_f32 v137, v162, v163
    v_cvt_pk_bf16_f32 v138, v164, v165
    v_cvt_pk_bf16_f32 v139, v166, v167
    ds_write_b128 v110, v[136:139] offset:24576
    v_pk_mul_f32 v[168:169], v[168:169], v[108:109] op_sel_hi:[1,0]
    v_pk_mul_f32 v[170:171], v[170:171], v[108:109] op_sel_hi:[1,0]
    v_pk_mul_f32 v[172:173], v[172:173], v[108:109] op_sel_hi:[1,0]
    v_pk_mul_f32 v[174:175], v[174:175], v[108:109] op_sel_hi:[1,0]
    v_cvt_pk_bf16_f32 v140, v168, v169
    v_cvt_pk_bf16_f32 v141, v170, v171
    v_cvt_pk_bf16_f32 v142, v172, v173
    v_cvt_pk_bf16_f32 v143, v174, v175
    ds_write_b128 v110, v[140:143] offset:28672
    v_pk_mul_f32 v[176:177], v[176:177], v[108:109] op_sel_hi:[1,0]
    v_pk_mul_f32 v[178:179], v[178:179], v[108:109] op_sel_hi:[1,0]
    v_pk_mul_f32 v[180:181], v[180:181], v[108:109] op_sel_hi:[1,0]
    v_pk_mul_f32 v[182:183], v[182:183], v[108:109] op_sel_hi:[1,0]
    v_cvt_pk_bf16_f32 v144, v176, v177
    v_cvt_pk_bf16_f32 v145, v178, v179
    v_cvt_pk_bf16_f32 v146, v180, v181
    v_cvt_pk_bf16_f32 v147, v182, v183
    ds_write_b128 v110, v[144:147] offset:32768
    v_pk_mul_f32 v[184:185], v[184:185], v[108:109] op_sel_hi:[1,0]
    v_pk_mul_f32 v[186:187], v[186:187], v[108:109] op_sel_hi:[1,0]
    v_pk_mul_f32 v[188:189], v[188:189], v[108:109] op_sel_hi:[1,0]
    v_pk_mul_f32 v[190:191], v[190:191], v[108:109] op_sel_hi:[1,0]
    v_cvt_pk_bf16_f32 v148, v184, v185
    v_cvt_pk_bf16_f32 v149, v186, v187
    v_cvt_pk_bf16_f32 v150, v188, v189
    v_cvt_pk_bf16_f32 v151, v190, v191
    ds_write_b128 v110, v[148:151] offset:36864
    v_pk_mul_f32 v[192:193], v[192:193], v[108:109] op_sel_hi:[1,0]
    v_pk_mul_f32 v[194:195], v[194:195], v[108:109] op_sel_hi:[1,0]
    v_pk_mul_f32 v[196:197], v[196:197], v[108:109] op_sel_hi:[1,0]
    v_pk_mul_f32 v[198:199], v[198:199], v[108:109] op_sel_hi:[1,0]
    v_cvt_pk_bf16_f32 v152, v192, v193
    v_cvt_pk_bf16_f32 v153, v194, v195
    v_cvt_pk_bf16_f32 v154, v196, v197
    v_cvt_pk_bf16_f32 v155, v198, v199
    ds_write_b128 v110, v[152:155] offset:40960
    v_pk_mul_f32 v[200:201], v[200:201], v[108:109] op_sel_hi:[1,0]
    v_pk_mul_f32 v[202:203], v[202:203], v[108:109] op_sel_hi:[1,0]
    v_pk_mul_f32 v[204:205], v[204:205], v[108:109] op_sel_hi:[1,0]
    v_pk_mul_f32 v[206:207], v[206:207], v[108:109] op_sel_hi:[1,0]
    v_cvt_pk_bf16_f32 v156, v200, v201
    v_cvt_pk_bf16_f32 v157, v202, v203
    v_cvt_pk_bf16_f32 v158, v204, v205
    v_cvt_pk_bf16_f32 v159, v206, v207
    ds_write_b128 v110, v[156:159] offset:45056
    v_pk_mul_f32 v[208:209], v[208:209], v[108:109] op_sel_hi:[1,0]
    v_pk_mul_f32 v[210:211], v[210:211], v[108:109] op_sel_hi:[1,0]
    v_pk_mul_f32 v[212:213], v[212:213], v[108:109] op_sel_hi:[1,0]
    v_pk_mul_f32 v[214:215], v[214:215], v[108:109] op_sel_hi:[1,0]
    v_cvt_pk_bf16_f32 v160, v208, v209
    v_cvt_pk_bf16_f32 v161, v210, v211
    v_cvt_pk_bf16_f32 v162, v212, v213
    v_cvt_pk_bf16_f32 v163, v214, v215
    s_waitcnt lgkmcnt(7)
    ds_write_b128 v110, v[160:163] offset:49152
    v_pk_mul_f32 v[216:217], v[216:217], v[108:109] op_sel_hi:[1,0]
    v_pk_mul_f32 v[218:219], v[218:219], v[108:109] op_sel_hi:[1,0]
    v_pk_mul_f32 v[220:221], v[220:221], v[108:109] op_sel_hi:[1,0]
    v_pk_mul_f32 v[222:223], v[222:223], v[108:109] op_sel_hi:[1,0]
    v_cvt_pk_bf16_f32 v164, v216, v217
    v_cvt_pk_bf16_f32 v165, v218, v219
    v_cvt_pk_bf16_f32 v166, v220, v221
    v_cvt_pk_bf16_f32 v167, v222, v223
    ds_write_b128 v110, v[164:167] offset:53248
    v_pk_mul_f32 v[224:225], v[224:225], v[108:109] op_sel_hi:[1,0]
    v_pk_mul_f32 v[226:227], v[226:227], v[108:109] op_sel_hi:[1,0]
    v_pk_mul_f32 v[228:229], v[228:229], v[108:109] op_sel_hi:[1,0]
    v_pk_mul_f32 v[230:231], v[230:231], v[108:109] op_sel_hi:[1,0]
    v_cvt_pk_bf16_f32 v168, v224, v225
    v_cvt_pk_bf16_f32 v169, v226, v227
    v_cvt_pk_bf16_f32 v170, v228, v229
    v_cvt_pk_bf16_f32 v171, v230, v231
    ds_write_b128 v110, v[168:171] offset:57344
    v_pk_mul_f32 v[232:233], v[232:233], v[108:109] op_sel_hi:[1,0]
    v_pk_mul_f32 v[234:235], v[234:235], v[108:109] op_sel_hi:[1,0]
    v_pk_mul_f32 v[236:237], v[236:237], v[108:109] op_sel_hi:[1,0]
    v_pk_mul_f32 v[238:239], v[238:239], v[108:109] op_sel_hi:[1,0]
    v_cvt_pk_bf16_f32 v172, v232, v233
    v_cvt_pk_bf16_f32 v173, v234, v235
    v_cvt_pk_bf16_f32 v174, v236, v237
    v_cvt_pk_bf16_f32 v175, v238, v239
    ds_write_b128 v110, v[172:175] offset:61440
    v_pk_mul_f32 v[240:241], v[240:241], v[108:109] op_sel_hi:[1,0]
    v_pk_mul_f32 v[242:243], v[242:243], v[108:109] op_sel_hi:[1,0]
    v_pk_mul_f32 v[244:245], v[244:245], v[108:109] op_sel_hi:[1,0]
    v_pk_mul_f32 v[246:247], v[246:247], v[108:109] op_sel_hi:[1,0]
    v_cvt_pk_bf16_f32 v176, v240, v241
    v_cvt_pk_bf16_f32 v177, v242, v243
    v_cvt_pk_bf16_f32 v178, v244, v245
    v_cvt_pk_bf16_f32 v179, v246, v247
    ds_write_b128 v111, v[176:179] offset:0
    v_pk_mul_f32 v[248:249], v[248:249], v[108:109] op_sel_hi:[1,0]
    v_pk_mul_f32 v[250:251], v[250:251], v[108:109] op_sel_hi:[1,0]
    v_pk_mul_f32 v[252:253], v[252:253], v[108:109] op_sel_hi:[1,0]
    v_pk_mul_f32 v[254:255], v[254:255], v[108:109] op_sel_hi:[1,0]
    v_cvt_pk_bf16_f32 v180, v248, v249
    v_cvt_pk_bf16_f32 v181, v250, v251
    v_cvt_pk_bf16_f32 v182, v252, v253
    v_cvt_pk_bf16_f32 v183, v254, v255
    ds_write_b128 v111, v[180:183] offset:4096
    s_mov_b32 s68, s34
    s_mov_b32 s69, s35
    s_mov_b32 s70, 256
    s_mov_b32 s71, 0x00020000
    v_mov_b32 v15, 1
    s_waitcnt vmcnt(8) lgkmcnt(0)
    s_barrier
    ds_read_b128 v[184:187], v46 offset:0
    ds_read_b128 v[188:191], v47 offset:0
    ds_read_b128 v[192:195], v46 offset:2048
    ds_read_b128 v[196:199], v47 offset:2048
    ds_read_b128 v[200:203], v46 offset:4096
    ds_read_b128 v[204:207], v47 offset:4096
    ds_read_b128 v[208:211], v46 offset:6144
    ds_read_b128 v[212:215], v47 offset:6144
    ds_read_b128 v[216:219], v46 offset:8192
    ds_read_b128 v[220:223], v47 offset:8192
    ds_read_b128 v[224:227], v46 offset:10240
    ds_read_b128 v[228:231], v47 offset:10240
    ds_read_b128 v[232:235], v46 offset:12288
    ds_read_b128 v[236:239], v47 offset:12288
    s_waitcnt lgkmcnt(13)
    v_mfma_f32_16x16x32_bf16 v[96:99], v[112:115], v[184:187], 0
    ds_read_b128 v[240:243], v46 offset:14336
    s_waitcnt lgkmcnt(13)
    v_mfma_f32_16x16x32_bf16 v[100:103], v[116:119], v[188:191], 0
    ds_read_b128 v[244:247], v47 offset:14336
    s_waitcnt lgkmcnt(13)
    v_mfma_f32_16x16x32_bf16 v[96:99], v[120:123], v[192:195], v[96:99]
    ds_read_b128 v[248:251], v48 offset:0
    s_waitcnt lgkmcnt(13)
    v_mfma_f32_16x16x32_bf16 v[100:103], v[124:127], v[196:199], v[100:103]
    ds_read_b128 v[252:255], v49 offset:0
    s_waitcnt lgkmcnt(13)
    v_mfma_f32_16x16x32_bf16 v[96:99], v[128:131], v[200:203], v[96:99]
    ds_read_b128 v[16:19], v42 offset:0
    s_waitcnt lgkmcnt(13)
    v_mfma_f32_16x16x32_bf16 v[100:103], v[132:135], v[204:207], v[100:103]
    ds_read_b128 v[20:23], v43 offset:0
    s_waitcnt lgkmcnt(13)
    v_mfma_f32_16x16x32_bf16 v[96:99], v[136:139], v[208:211], v[96:99]
    ds_read_b128 a[0:3], v7 offset:0
    s_waitcnt lgkmcnt(13)
    v_mfma_f32_16x16x32_bf16 v[100:103], v[140:143], v[212:215], v[100:103]
    ds_read_b128 a[4:7], v7 offset:1024
    s_waitcnt lgkmcnt(13)
    v_mfma_f32_16x16x32_bf16 v[96:99], v[144:147], v[216:219], v[96:99]
    ds_read_b128 a[8:11], v7 offset:2048
    s_waitcnt lgkmcnt(13)
    v_mfma_f32_16x16x32_bf16 v[100:103], v[148:151], v[220:223], v[100:103]
    ds_read_b128 a[12:15], v7 offset:3072
    s_waitcnt lgkmcnt(13)
    v_mfma_f32_16x16x32_bf16 v[96:99], v[152:155], v[224:227], v[96:99]
    ds_read_b128 a[16:19], v7 offset:4096
    s_waitcnt lgkmcnt(13)
    v_mfma_f32_16x16x32_bf16 v[100:103], v[156:159], v[228:231], v[100:103]
    ds_read_b128 a[20:23], v7 offset:5120
    s_waitcnt lgkmcnt(13)
    v_mfma_f32_16x16x32_bf16 v[96:99], v[160:163], v[232:235], v[96:99]
    ds_read_b128 a[24:27], v7 offset:6144
    s_waitcnt lgkmcnt(13)
    v_mfma_f32_16x16x32_bf16 v[100:103], v[164:167], v[236:239], v[100:103]
    ds_read_b128 a[28:31], v7 offset:7168
    s_waitcnt lgkmcnt(13)
    v_mfma_f32_16x16x32_bf16 v[96:99], v[168:171], v[240:243], v[96:99]
    s_waitcnt lgkmcnt(12)
    v_mfma_f32_16x16x32_bf16 v[100:103], v[172:175], v[244:247], v[100:103]
    s_waitcnt lgkmcnt(11)
    v_mfma_f32_16x16x32_bf16 v[96:99], v[176:179], v[248:251], v[96:99]
    s_waitcnt lgkmcnt(10)
    v_mfma_f32_16x16x32_bf16 v[100:103], v[180:183], v[252:255], v[100:103]
    v_lshlrev_b32 v104, 4, v11
    s_lshl_b32 s74, s5, 10
    s_add_u32 s74, s74, 147456
    v_add_u32 v105, s74, v104
    v_add_u32 v104, 147456, v104
    s_nop 4
    v_add_f32 v96, v96, v100
    v_add_f32 v97, v97, v101
    v_add_f32 v98, v98, v102
    v_add_f32 v99, v99, v103
    ds_write_b128 v105, v[96:99]
    s_waitcnt vmcnt(8) lgkmcnt(0)
    s_barrier
    v_mfma_f32_16x16x32_bf16 v[64:67], a[0:3], v[16:19], 0
    ds_read_b128 v[24:27], v42 offset:8192
    ds_read_b128 v[28:31], v43 offset:8192
    v_mfma_f32_16x16x32_bf16 v[68:71], a[4:7], v[16:19], 0
    s_add_u32 m0, s36, 56448
    ds_read_b128 a[32:35], v7 offset:8192
    v_mfma_f32_16x16x32_bf16 v[72:75], a[8:11], v[16:19], 0
    global_load_lds_dwordx4 v[32:33], off offset:896
    ds_read_b128 a[36:39], v7 offset:9216
    v_mfma_f32_16x16x32_bf16 v[76:79], a[12:15], v[16:19], 0
    global_load_lds_dwordx4 v[34:35], off offset:1920
    ds_read_b128 a[40:43], v7 offset:10240
    v_mfma_f32_16x16x32_bf16 v[64:67], a[16:19], v[20:23], v[64:67]
    ds_read_b128 a[44:47], v7 offset:11264
    ds_read_b128 a[48:51], v7 offset:12288
    v_mfma_f32_16x16x32_bf16 v[68:71], a[20:23], v[20:23], v[68:71]
    ds_read_b128 a[52:55], v7 offset:13312
    ds_read_b128 a[56:59], v7 offset:14336
    v_mfma_f32_16x16x32_bf16 v[72:75], a[24:27], v[20:23], v[72:75]
    ds_read_b128 a[60:63], v7 offset:15360
    ds_read_b128 v[80:83], v104 offset:0
    v_mfma_f32_16x16x32_bf16 v[76:79], a[28:31], v[20:23], v[76:79]
    ds_read_b128 v[84:87], v104 offset:1024
    ds_read_b128 v[88:91], v104 offset:2048
    ds_read_b128 v[92:95], v104 offset:3072
    s_waitcnt lgkmcnt(4)
    v_mfma_f32_16x16x32_bf16 v[64:67], a[32:35], v[24:27], v[64:67]
    ds_read_b128 v[16:19], v42 offset:16384
    ds_read_b128 v[20:23], v43 offset:16384
    v_mfma_f32_16x16x32_bf16 v[68:71], a[36:39], v[24:27], v[68:71]
    s_add_u32 m0, s36, 64512
    ds_read_b128 a[64:67], v7 offset:16384
    v_mfma_f32_16x16x32_bf16 v[72:75], a[40:43], v[24:27], v[72:75]
    global_load_lds_dwordx4 v[32:33], off offset:1024
    ds_read_b128 a[68:71], v7 offset:17408
    v_mfma_f32_16x16x32_bf16 v[76:79], a[44:47], v[24:27], v[76:79]
    global_load_lds_dwordx4 v[34:35], off offset:2048
    ds_read_b128 a[72:75], v7 offset:18432
    v_mfma_f32_16x16x32_bf16 v[64:67], a[48:51], v[28:31], v[64:67]
    ds_read_b128 a[76:79], v7 offset:19456
    ds_read_b128 a[80:83], v7 offset:20480
    v_mfma_f32_16x16x32_bf16 v[68:71], a[52:55], v[28:31], v[68:71]
    ds_read_b128 a[84:87], v7 offset:21504
    ds_read_b128 a[88:91], v7 offset:22528
    v_mfma_f32_16x16x32_bf16 v[72:75], a[56:59], v[28:31], v[72:75]
    ds_read_b128 a[92:95], v7 offset:23552
    v_mfma_f32_16x16x32_bf16 v[76:79], a[60:63], v[28:31], v[76:79]
    s_waitcnt lgkmcnt(0)
    v_mfma_f32_16x16x32_bf16 v[64:67], a[64:67], v[16:19], v[64:67]
    ds_read_b128 v[24:27], v42 offset:24576
    ds_read_b128 v[28:31], v43 offset:24576
    v_mfma_f32_16x16x32_bf16 v[68:71], a[68:71], v[16:19], v[68:71]
    s_add_u32 m0, s36, 0
    ds_read_b128 a[96:99], v7 offset:24576
    v_mfma_f32_16x16x32_bf16 v[72:75], a[72:75], v[16:19], v[72:75]
    buffer_load_dwordx4 v1, s[12:15], s40 offen lds
    ds_read_b128 a[100:103], v7 offset:25600
    v_mfma_f32_16x16x32_bf16 v[76:79], a[76:79], v[16:19], v[76:79]
    buffer_load_dwordx4 v1, s[16:19], s40 offen offset:1024 lds
    ds_read_b128 a[104:107], v7 offset:26624
    v_mfma_f32_16x16x32_bf16 v[64:67], a[80:83], v[20:23], v[64:67]
    ds_read_b128 a[108:111], v7 offset:27648
    ds_read_b128 a[112:115], v7 offset:28672
    v_mfma_f32_16x16x32_bf16 v[68:71], a[84:87], v[20:23], v[68:71]
    ds_read_b128 a[116:119], v7 offset:29696
    ds_read_b128 a[120:123], v7 offset:30720
    v_mfma_f32_16x16x32_bf16 v[72:75], a[88:91], v[20:23], v[72:75]
    ds_read_b128 a[124:127], v7 offset:31744
    v_mfma_f32_16x16x32_bf16 v[76:79], a[92:95], v[20:23], v[76:79]
    s_waitcnt vmcnt(8) lgkmcnt(0)
    s_barrier
    v_mfma_f32_16x16x32_bf16 v[64:67], a[96:99], v[24:27], v[64:67]
    ds_read_b128 v[16:19], v42 offset:32768
    ds_read_b128 v[20:23], v43 offset:32768
    v_mfma_f32_16x16x32_bf16 v[68:71], a[100:103], v[24:27], v[68:71]
    s_add_u32 m0, s36, 8192
    ds_read_b128 a[128:131], v7 offset:32768
    v_mfma_f32_16x16x32_bf16 v[72:75], a[104:107], v[24:27], v[72:75]
    buffer_load_dwordx4 v1, s[12:15], s41 offen lds
    ds_read_b128 a[132:135], v7 offset:33792
    v_mfma_f32_16x16x32_bf16 v[76:79], a[108:111], v[24:27], v[76:79]
    buffer_load_dwordx4 v1, s[16:19], s41 offen offset:1024 lds
    ds_read_b128 a[136:139], v7 offset:34816
    v_mfma_f32_16x16x32_bf16 v[64:67], a[112:115], v[28:31], v[64:67]
    ds_read_b128 a[140:143], v7 offset:35840
    ds_read_b128 a[144:147], v7 offset:36864
    v_mfma_f32_16x16x32_bf16 v[68:71], a[116:119], v[28:31], v[68:71]
    ds_read_b128 a[148:151], v7 offset:37888
    ds_read_b128 a[152:155], v7 offset:38912
    v_mfma_f32_16x16x32_bf16 v[72:75], a[120:123], v[28:31], v[72:75]
    ds_read_b128 a[156:159], v7 offset:39936
    v_mfma_f32_16x16x32_bf16 v[76:79], a[124:127], v[28:31], v[76:79]
    s_waitcnt lgkmcnt(0)
    v_mfma_f32_16x16x32_bf16 v[64:67], a[128:131], v[16:19], v[64:67]
    ds_read_b128 v[24:27], v42 offset:40960
    ds_read_b128 v[28:31], v43 offset:40960
    v_mfma_f32_16x16x32_bf16 v[68:71], a[132:135], v[16:19], v[68:71]
    s_add_u32 m0, s36, 16384
    ds_read_b128 a[160:163], v7 offset:40960
    v_mfma_f32_16x16x32_bf16 v[72:75], a[136:139], v[16:19], v[72:75]
    buffer_load_dwordx4 v1, s[12:15], s42 offen lds
    ds_read_b128 a[164:167], v7 offset:41984
    v_mfma_f32_16x16x32_bf16 v[76:79], a[140:143], v[16:19], v[76:79]
    buffer_load_dwordx4 v1, s[16:19], s42 offen offset:1024 lds
    ds_read_b128 a[168:171], v7 offset:43008
    v_mfma_f32_16x16x32_bf16 v[64:67], a[144:147], v[20:23], v[64:67]
    ds_read_b128 a[172:175], v7 offset:44032
    ds_read_b128 a[176:179], v7 offset:45056
    v_mfma_f32_16x16x32_bf16 v[68:71], a[148:151], v[20:23], v[68:71]
    ds_read_b128 a[180:183], v7 offset:46080
    ds_read_b128 a[184:187], v7 offset:47104
    v_mfma_f32_16x16x32_bf16 v[72:75], a[152:155], v[20:23], v[72:75]
    ds_read_b128 a[188:191], v7 offset:48128
    v_mfma_f32_16x16x32_bf16 v[76:79], a[156:159], v[20:23], v[76:79]
    s_waitcnt lgkmcnt(0)
    v_mfma_f32_16x16x32_bf16 v[64:67], a[160:163], v[24:27], v[64:67]
    ds_read_b128 v[16:19], v42 offset:49152
    ds_read_b128 v[20:23], v43 offset:49152
    v_mfma_f32_16x16x32_bf16 v[68:71], a[164:167], v[24:27], v[68:71]
    s_add_u32 m0, s36, 24576
    ds_read_b128 a[192:195], v7 offset:49152
    v_mfma_f32_16x16x32_bf16 v[72:75], a[168:171], v[24:27], v[72:75]
    buffer_load_dwordx4 v1, s[12:15], s43 offen lds
    ds_read_b128 a[196:199], v7 offset:50176
    v_mfma_f32_16x16x32_bf16 v[76:79], a[172:175], v[24:27], v[76:79]
    buffer_load_dwordx4 v1, s[16:19], s43 offen offset:1024 lds
    ds_read_b128 a[200:203], v7 offset:51200
    v_mfma_f32_16x16x32_bf16 v[64:67], a[176:179], v[28:31], v[64:67]
    ds_read_b128 a[204:207], v7 offset:52224
    ds_read_b128 a[208:211], v7 offset:53248
    v_mfma_f32_16x16x32_bf16 v[68:71], a[180:183], v[28:31], v[68:71]
    ds_read_b128 a[212:215], v7 offset:54272
    ds_read_b128 a[216:219], v7 offset:55296
    v_mfma_f32_16x16x32_bf16 v[72:75], a[184:187], v[28:31], v[72:75]
    ds_read_b128 a[220:223], v7 offset:56320
    v_mfma_f32_16x16x32_bf16 v[76:79], a[188:191], v[28:31], v[76:79]
    s_waitcnt vmcnt(6) lgkmcnt(0)
    s_barrier
    v_mfma_f32_16x16x32_bf16 v[64:67], a[192:195], v[16:19], v[64:67]
    ds_read_b128 v[24:27], v42 offset:57344
    ds_read_b128 v[28:31], v43 offset:57344
    v_mfma_f32_16x16x32_bf16 v[68:71], a[196:199], v[16:19], v[68:71]
    s_add_u32 m0, s36, 32768
    ds_read_b128 a[224:227], v7 offset:57344
    v_mfma_f32_16x16x32_bf16 v[72:75], a[200:203], v[16:19], v[72:75]
    buffer_load_dwordx4 v1, s[12:15], s44 offen lds
    ds_read_b128 a[228:231], v7 offset:58368
    v_mfma_f32_16x16x32_bf16 v[76:79], a[204:207], v[16:19], v[76:79]
    buffer_load_dwordx4 v1, s[16:19], s44 offen offset:1024 lds
    ds_read_b128 a[232:235], v7 offset:59392
    v_mfma_f32_16x16x32_bf16 v[64:67], a[208:211], v[20:23], v[64:67]
    ds_read_b128 a[236:239], v7 offset:60416
    ds_read_b128 a[240:243], v7 offset:61440
    v_mfma_f32_16x16x32_bf16 v[68:71], a[212:215], v[20:23], v[68:71]
    ds_read_b128 a[244:247], v7 offset:62464
    ds_read_b128 a[248:251], v7 offset:63488
    v_mfma_f32_16x16x32_bf16 v[72:75], a[216:219], v[20:23], v[72:75]
    ds_read_b128 a[252:255], v7 offset:64512
    v_mfma_f32_16x16x32_bf16 v[76:79], a[220:223], v[20:23], v[76:79]
    s_waitcnt lgkmcnt(0)
    v_mfma_f32_16x16x32_bf16 v[64:67], a[224:227], v[24:27], v[64:67]
    ds_read_b128 v[16:19], v44 offset:0
    ds_read_b128 v[20:23], v45 offset:0
    v_mfma_f32_16x16x32_bf16 v[68:71], a[228:231], v[24:27], v[68:71]
    s_add_u32 m0, s36, 40960
    ds_read_b128 v[224:227], v8 offset:0
    v_mfma_f32_16x16x32_bf16 v[72:75], a[232:235], v[24:27], v[72:75]
    buffer_load_dwordx4 v1, s[12:15], s45 offen lds
    ds_read_b128 v[228:231], v8 offset:1024
    v_mfma_f32_16x16x32_bf16 v[76:79], a[236:239], v[24:27], v[76:79]
    buffer_load_dwordx4 v1, s[16:19], s45 offen offset:1024 lds
    ds_read_b128 v[232:235], v8 offset:2048
    v_mfma_f32_16x16x32_bf16 v[64:67], a[240:243], v[28:31], v[64:67]
    ds_read_b128 v[236:239], v8 offset:3072
    ds_read_b128 v[240:243], v8 offset:4096
    v_mfma_f32_16x16x32_bf16 v[68:71], a[244:247], v[28:31], v[68:71]
    ds_read_b128 v[244:247], v8 offset:5120
    ds_read_b128 v[248:251], v8 offset:6144
    v_mfma_f32_16x16x32_bf16 v[72:75], a[248:251], v[28:31], v[72:75]
    ds_read_b128 v[252:255], v8 offset:7168
    v_mfma_f32_16x16x32_bf16 v[76:79], a[252:255], v[28:31], v[76:79]
    s_waitcnt lgkmcnt(0)
    v_mfma_f32_16x16x32_bf16 v[64:67], v[224:227], v[16:19], v[64:67]
    ds_read_b64_tr_b16 v[24:25], v2 offset:0
    ds_read_b64_tr_b16 v[26:27], v2 offset:512
    v_mfma_f32_16x16x32_bf16 v[68:71], v[228:231], v[16:19], v[68:71]
    ds_read_b64_tr_b16 v[28:29], v2 offset:1024
    ds_read_b64_tr_b16 v[30:31], v2 offset:1536
    v_mfma_f32_16x16x32_bf16 v[72:75], v[232:235], v[16:19], v[72:75]
    s_add_u32 m0, s36, 49152
    s_nop 0
    buffer_load_dwordx4 v1, s[12:15], s46 offen lds
    v_mfma_f32_16x16x32_bf16 v[76:79], v[236:239], v[16:19], v[76:79]
    buffer_load_dwordx4 v1, s[16:19], s46 offen offset:1024 lds
    v_mfma_f32_16x16x32_bf16 v[64:67], v[240:243], v[20:23], v[64:67]
    v_mfma_f32_16x16x32_bf16 v[68:71], v[244:247], v[20:23], v[68:71]
    v_mfma_f32_16x16x32_bf16 v[72:75], v[248:251], v[20:23], v[72:75]
    v_mfma_f32_16x16x32_bf16 v[76:79], v[252:255], v[20:23], v[76:79]
    s_waitcnt vmcnt(6) lgkmcnt(0)
    s_barrier
    v_mfma_f32_16x16x32_bf16 v[32:35], v[24:27], a[0:3], 0
    ds_read_b64_tr_b16 v[16:17], v2 offset:8192
    ds_read_b64_tr_b16 v[18:19], v2 offset:8704
    v_mfma_f32_16x16x32_bf16 v[48:51], v[28:31], a[0:3], 0
    ds_read_b64_tr_b16 v[20:21], v2 offset:9216
    ds_read_b64_tr_b16 v[22:23], v2 offset:9728
    v_mfma_f32_16x16x32_bf16 v[36:39], v[24:27], a[4:7], 0
    s_add_u32 m0, s36, 57344
    s_lshl_b32 s74, s76, 4
    v_mfma_f32_16x16x32_bf16 v[52:55], v[28:31], a[4:7], 0
    buffer_load_dwordx4 v1, s[12:15], s47 offen lds
    v_add_u32 v129, s74, v13
    v_mfma_f32_16x16x32_bf16 v[40:43], v[24:27], a[8:11], 0
    buffer_load_dwordx4 v1, s[16:19], s47 offen offset:1024 lds
    s_movk_i32 s75, 288
    v_mfma_f32_16x16x32_bf16 v[56:59], v[28:31], a[8:11], 0
    v_cmp_lt_u32 vcc, s75, v129
    v_mov_b32 v128, 1.0
    v_mfma_f32_16x16x32_bf16 v[44:47], v[24:27], a[12:15], 0
    v_lshlrev_b32 v130, 2, v129
    v_mov_b32 v131, -1.0
    v_mfma_f32_16x16x32_bf16 v[60:63], v[28:31], a[12:15], 0
    v_cndmask_b32 v128, v128, v131, vcc
    v_fma_f32 v132, v128, v76, v64
    s_waitcnt lgkmcnt(0)
    v_mfma_f32_16x16x32_bf16 v[32:35], v[16:19], a[16:19], v[32:35]
    ds_read_b64_tr_b16 v[24:25], v2 offset:16384
    ds_read_b64_tr_b16 v[26:27], v2 offset:16896
    v_mfma_f32_16x16x32_bf16 v[48:51], v[20:23], a[16:19], v[48:51]
    ds_read_b64_tr_b16 v[28:29], v2 offset:17408
    ds_read_b64_tr_b16 v[30:31], v2 offset:17920
    v_mfma_f32_16x16x32_bf16 v[36:39], v[16:19], a[20:23], v[36:39]
    s_add_u32 m0, s36, 65536
    v_fma_f32 v136, v128, v68, v72
    v_mfma_f32_16x16x32_bf16 v[52:55], v[20:23], a[20:23], v[52:55]
    buffer_load_dwordx4 v1, s[12:15], s48 offen lds
    v_fma_f32 v133, v128, v77, v65
    v_mfma_f32_16x16x32_bf16 v[40:43], v[16:19], a[24:27], v[40:43]
    buffer_load_dwordx4 v1, s[16:19], s48 offen offset:1024 lds
    v_fma_f32 v137, v128, v69, v73
    v_mfma_f32_16x16x32_bf16 v[56:59], v[20:23], a[24:27], v[56:59]
    v_fma_f32 v134, v128, v78, v66
    v_fma_f32 v138, v128, v70, v74
    v_mfma_f32_16x16x32_bf16 v[44:47], v[16:19], a[28:31], v[44:47]
    v_fma_f32 v135, v128, v79, v67
    v_fma_f32 v139, v128, v71, v75
    v_mfma_f32_16x16x32_bf16 v[60:63], v[20:23], a[28:31], v[60:63]
    v_add_f32 v140, v132, v136
    v_sub_f32 v144, v132, v136
    s_waitcnt lgkmcnt(0)
    v_mfma_f32_16x16x32_bf16 v[32:35], v[24:27], a[32:35], v[32:35]
    ds_read_b64_tr_b16 v[16:17], v2 offset:24576
    ds_read_b64_tr_b16 v[18:19], v2 offset:25088
    v_mfma_f32_16x16x32_bf16 v[48:51], v[28:31], a[32:35], v[48:51]
    ds_read_b64_tr_b16 v[20:21], v2 offset:25600
    ds_read_b64_tr_b16 v[22:23], v2 offset:26112
    v_mfma_f32_16x16x32_bf16 v[36:39], v[24:27], a[36:39], v[36:39]
    s_add_u32 m0, s36, 0
    v_add_f32 v141, v133, v137
    v_mfma_f32_16x16x32_bf16 v[52:55], v[28:31], a[36:39], v[52:55]
    buffer_load_dwordx4 v1, s[12:15], s49 offen lds
    v_sub_f32 v145, v133, v137
    v_mfma_f32_16x16x32_bf16 v[40:43], v[24:27], a[40:43], v[40:43]
    buffer_load_dwordx4 v1, s[16:19], s49 offen offset:1024 lds
    v_add_f32 v142, v134, v138
    v_mfma_f32_16x16x32_bf16 v[56:59], v[28:31], a[40:43], v[56:59]
    v_sub_f32 v146, v134, v138
    v_add_f32 v143, v135, v139
    v_mfma_f32_16x16x32_bf16 v[44:47], v[24:27], a[44:47], v[44:47]
    v_sub_f32 v147, v135, v139
    s_cmp_eq_u32 s4, 0
    s_cselect_b32 s74, 16, 0
    v_mfma_f32_16x16x32_bf16 v[60:63], v[28:31], a[44:47], v[60:63]
    v_cmp_gt_u32 vcc, s74, v11
    v_add_f32 v132, v64, v68
    s_waitcnt vmcnt(6) lgkmcnt(0)
    s_barrier
    v_mfma_f32_16x16x32_bf16 v[32:35], v[16:19], a[48:51], v[32:35]
    ds_read_b64_tr_b16 v[24:25], v2 offset:32768
    ds_read_b64_tr_b16 v[26:27], v2 offset:33280
    v_mfma_f32_16x16x32_bf16 v[48:51], v[20:23], a[48:51], v[48:51]
    ds_read_b64_tr_b16 v[28:29], v2 offset:33792
    ds_read_b64_tr_b16 v[30:31], v2 offset:34304
    v_mfma_f32_16x16x32_bf16 v[36:39], v[16:19], a[52:55], v[36:39]
    s_add_u32 m0, s36, 8192
    v_sub_f32 v133, v64, v68
    v_mfma_f32_16x16x32_bf16 v[52:55], v[20:23], a[52:55], v[52:55]
    buffer_load_dwordx4 v1, s[12:15], s50 offen lds
    v_fma_f32 v148, v128, v76, v72
    v_mfma_f32_16x16x32_bf16 v[40:43], v[16:19], a[56:59], v[40:43]
    buffer_load_dwordx4 v1, s[16:19], s50 offen offset:1024 lds
    v_cndmask_b32 v140, v140, v132, vcc
    v_mfma_f32_16x16x32_bf16 v[56:59], v[20:23], a[56:59], v[56:59]
    v_cndmask_b32 v144, v144, v133, vcc
    v_mov_b32 v131, 0x7ffffff0
    v_mfma_f32_16x16x32_bf16 v[44:47], v[16:19], a[60:63], v[44:47]
    v_cndmask_b32 v130, v131, v130, vcc
    v_cvt_pk_bf16_f32 v152, v140, v141
    v_mfma_f32_16x16x32_bf16 v[60:63], v[20:23], a[60:63], v[60:63]
    v_cvt_pk_bf16_f32 v153, v142, v143
    v_cvt_pk_bf16_f32 v154, v144, v145
    s_waitcnt lgkmcnt(0)
    v_mfma_f32_16x16x32_bf16 v[32:35], v[24:27], a[64:67], v[32:35]
    ds_read_b64_tr_b16 v[16:17], v2 offset:40960
    ds_read_b64_tr_b16 v[18:19], v2 offset:41472
    v_mfma_f32_16x16x32_bf16 v[48:51], v[28:31], a[64:67], v[48:51]
    ds_read_b64_tr_b16 v[20:21], v2 offset:41984
    ds_read_b64_tr_b16 v[22:23], v2 offset:42496
    v_mfma_f32_16x16x32_bf16 v[36:39], v[24:27], a[68:71], v[36:39]
    s_add_u32 m0, s36, 16384
    v_cvt_pk_bf16_f32 v155, v146, v147
    v_mfma_f32_16x16x32_bf16 v[52:55], v[28:31], a[68:71], v[52:55]
    buffer_load_dwordx4 v1, s[12:15], s51 offen lds
    s_lshl_b32 s74, s76, 14
    v_mfma_f32_16x16x32_bf16 v[40:43], v[24:27], a[72:75], v[40:43]
    buffer_load_dwordx4 v1, s[16:19], s51 offen offset:1024 lds
    s_lshr_b32 s75, s4, 1
    v_mfma_f32_16x16x32_bf16 v[56:59], v[28:31], a[72:75], v[56:59]
    s_lshl_b32 s75, s75, 10
    s_add_u32 s74, s74, s75
    v_mfma_f32_16x16x32_bf16 v[44:47], v[24:27], a[76:79], v[44:47]
    s_add_u32 s75, s74, 589824
    buffer_store_dwordx2 v[152:153], v12, s[20:23], s74 offen sc1
    v_mfma_f32_16x16x32_bf16 v[60:63], v[28:31], a[76:79], v[60:63]
    buffer_store_dwordx2 v[154:155], v12, s[20:23], s75 offen sc1
    s_mov_b32 s74, 1179648
    s_waitcnt lgkmcnt(0)
    v_mfma_f32_16x16x32_bf16 v[32:35], v[16:19], a[80:83], v[32:35]
    ds_read_b64_tr_b16 v[24:25], v2 offset:49152
    ds_read_b64_tr_b16 v[26:27], v2 offset:49664
    v_mfma_f32_16x16x32_bf16 v[48:51], v[20:23], a[80:83], v[48:51]
    ds_read_b64_tr_b16 v[28:29], v2 offset:50176
    ds_read_b64_tr_b16 v[30:31], v2 offset:50688
    v_mfma_f32_16x16x32_bf16 v[36:39], v[16:19], a[84:87], v[36:39]
    s_add_u32 m0, s36, 24576
    buffer_store_dword v148, v130, s[20:23], s74 offen sc1
    v_mfma_f32_16x16x32_bf16 v[52:55], v[20:23], a[84:87], v[52:55]
    buffer_load_dwordx4 v1, s[12:15], s52 offen lds
    s_lshl_b32 s74, s77, 4
    v_mfma_f32_16x16x32_bf16 v[40:43], v[16:19], a[88:91], v[40:43]
    buffer_load_dwordx4 v1, s[16:19], s52 offen offset:1024 lds
    v_add_u32 v129, s74, v13
    v_mfma_f32_16x16x32_bf16 v[56:59], v[20:23], a[88:91], v[56:59]
    s_movk_i32 s75, 288
    v_cmp_lt_u32 vcc, s75, v129
    v_mfma_f32_16x16x32_bf16 v[44:47], v[16:19], a[92:95], v[44:47]
    v_mov_b32 v128, 1.0
    v_lshlrev_b32 v130, 2, v129
    v_mfma_f32_16x16x32_bf16 v[60:63], v[20:23], a[92:95], v[60:63]
    v_mov_b32 v131, -1.0
    s_waitcnt vmcnt(9) lgkmcnt(0)
    s_barrier
    v_mfma_f32_16x16x32_bf16 v[32:35], v[24:27], a[96:99], v[32:35]
    ds_read_b64_tr_b16 v[16:17], v2 offset:57344
    ds_read_b64_tr_b16 v[18:19], v2 offset:57856
    v_mfma_f32_16x16x32_bf16 v[48:51], v[28:31], a[96:99], v[48:51]
    ds_read_b64_tr_b16 v[20:21], v2 offset:58368
    ds_read_b64_tr_b16 v[22:23], v2 offset:58880
    v_mfma_f32_16x16x32_bf16 v[36:39], v[24:27], a[100:103], v[36:39]
    s_add_u32 m0, s36, 32768
    v_cndmask_b32 v128, v128, v131, vcc
    v_mfma_f32_16x16x32_bf16 v[52:55], v[28:31], a[100:103], v[52:55]
    buffer_load_dwordx4 v1, s[12:15], s53 offen lds
    v_fma_f32 v132, v128, v92, v80
    v_mfma_f32_16x16x32_bf16 v[40:43], v[24:27], a[104:107], v[40:43]
    buffer_load_dwordx4 v1, s[16:19], s53 offen offset:1024 lds
    v_fma_f32 v136, v128, v84, v88
    v_mfma_f32_16x16x32_bf16 v[56:59], v[28:31], a[104:107], v[56:59]
    v_fma_f32 v133, v128, v93, v81
    v_fma_f32 v137, v128, v85, v89
    v_mfma_f32_16x16x32_bf16 v[44:47], v[24:27], a[108:111], v[44:47]
    v_fma_f32 v134, v128, v94, v82
    v_fma_f32 v138, v128, v86, v90
    v_mfma_f32_16x16x32_bf16 v[60:63], v[28:31], a[108:111], v[60:63]
    v_fma_f32 v135, v128, v95, v83
    v_fma_f32 v139, v128, v87, v91
    s_waitcnt lgkmcnt(0)
    v_mfma_f32_16x16x32_bf16 v[32:35], v[16:19], a[112:115], v[32:35]
    ds_read_b64_tr_b16 v[24:25], v3 offset:0
    ds_read_b64_tr_b16 v[26:27], v3 offset:512
    v_mfma_f32_16x16x32_bf16 v[48:51], v[20:23], a[112:115], v[48:51]
    ds_read_b64_tr_b16 v[28:29], v3 offset:1024
    ds_read_b64_tr_b16 v[30:31], v3 offset:1536
    v_mfma_f32_16x16x32_bf16 v[36:39], v[16:19], a[116:119], v[36:39]
    s_add_u32 m0, s36, 40960
    v_add_f32 v140, v132, v136
    v_mfma_f32_16x16x32_bf16 v[52:55], v[20:23], a[116:119], v[52:55]
    buffer_load_dwordx4 v1, s[12:15], s54 offen lds
    v_sub_f32 v144, v132, v136
    v_mfma_f32_16x16x32_bf16 v[40:43], v[16:19], a[120:123], v[40:43]
    buffer_load_dwordx4 v1, s[16:19], s54 offen offset:1024 lds
    v_add_f32 v141, v133, v137
    v_mfma_f32_16x16x32_bf16 v[56:59], v[20:23], a[120:123], v[56:59]
    v_sub_f32 v145, v133, v137
    v_add_f32 v142, v134, v138
    v_mfma_f32_16x16x32_bf16 v[44:47], v[16:19], a[124:127], v[44:47]
    v_sub_f32 v146, v134, v138
    v_add_f32 v143, v135, v139
    v_mfma_f32_16x16x32_bf16 v[60:63], v[20:23], a[124:127], v[60:63]
    v_sub_f32 v147, v135, v139
    s_cmp_eq_u32 s4, 0
    s_cselect_b32 s74, 16, 0
    s_waitcnt lgkmcnt(0)
    v_mfma_f32_16x16x32_bf16 v[32:35], v[24:27], a[128:131], v[32:35]
    ds_read_b64_tr_b16 v[16:17], v2 offset:0
    ds_read_b64_tr_b16 v[18:19], v2 offset:512
    v_mfma_f32_16x16x32_bf16 v[48:51], v[28:31], a[128:131], v[48:51]
    ds_read_b64_tr_b16 v[20:21], v2 offset:1024
    ds_read_b64_tr_b16 v[22:23], v2 offset:1536
    v_mfma_f32_16x16x32_bf16 v[36:39], v[24:27], a[132:135], v[36:39]
    s_add_u32 m0, s36, 49152
    v_cmp_gt_u32 vcc, s74, v11
    v_mfma_f32_16x16x32_bf16 v[52:55], v[28:31], a[132:135], v[52:55]
    buffer_load_dwordx4 v1, s[12:15], s55 offen lds
    v_add_f32 v132, v80, v84
    v_mfma_f32_16x16x32_bf16 v[40:43], v[24:27], a[136:139], v[40:43]
    buffer_load_dwordx4 v1, s[16:19], s55 offen offset:1024 lds
    v_sub_f32 v133, v80, v84
    v_mfma_f32_16x16x32_bf16 v[56:59], v[28:31], a[136:139], v[56:59]
    v_fma_f32 v148, v128, v92, v88
    v_cndmask_b32 v140, v140, v132, vcc
    v_mfma_f32_16x16x32_bf16 v[44:47], v[24:27], a[140:143], v[44:47]
    v_cndmask_b32 v144, v144, v133, vcc
    v_mov_b32 v131, 0x7ffffff0
    v_mfma_f32_16x16x32_bf16 v[60:63], v[28:31], a[140:143], v[60:63]
    v_cndmask_b32 v130, v131, v130, vcc
    v_cvt_pk_bf16_f32 v152, v140, v141
    s_waitcnt vmcnt(6) lgkmcnt(0)
    s_barrier
    v_mfma_f32_16x16x32_bf16 v[32:35], v[16:19], a[144:147], v[32:35]
    ds_read_b64_tr_b16 v[24:25], v2 offset:8192
    ds_read_b64_tr_b16 v[26:27], v2 offset:8704
    v_mfma_f32_16x16x32_bf16 v[48:51], v[20:23], a[144:147], v[48:51]
    ds_read_b64_tr_b16 v[28:29], v2 offset:9216
    ds_read_b64_tr_b16 v[30:31], v2 offset:9728
    v_mfma_f32_16x16x32_bf16 v[36:39], v[16:19], a[148:151], v[36:39]
    s_add_u32 m0, s36, 57344
    v_cvt_pk_bf16_f32 v153, v142, v143
    v_mfma_f32_16x16x32_bf16 v[52:55], v[20:23], a[148:151], v[52:55]
    buffer_load_dwordx4 v1, s[12:15], s56 offen lds
    v_cvt_pk_bf16_f32 v154, v144, v145
    v_mfma_f32_16x16x32_bf16 v[40:43], v[16:19], a[152:155], v[40:43]
    buffer_load_dwordx4 v1, s[16:19], s56 offen offset:1024 lds
    v_cvt_pk_bf16_f32 v155, v146, v147
    v_mfma_f32_16x16x32_bf16 v[56:59], v[20:23], a[152:155], v[56:59]
    s_lshl_b32 s74, s77, 14
    s_lshr_b32 s75, s4, 1
    v_mfma_f32_16x16x32_bf16 v[44:47], v[16:19], a[156:159], v[44:47]
    s_lshl_b32 s75, s75, 10
    s_add_u32 s74, s74, s75
    v_mfma_f32_16x16x32_bf16 v[60:63], v[20:23], a[156:159], v[60:63]
    s_lshr_b32 s75, s3, 2
    s_or_b32 s75, s75, s5
    s_waitcnt lgkmcnt(0)
    v_mfma_f32_16x16x32_bf16 v[32:35], v[24:27], a[160:163], v[32:35]
    ds_read_b64_tr_b16 v[16:17], v2 offset:16384
    ds_read_b64_tr_b16 v[18:19], v2 offset:16896
    v_mfma_f32_16x16x32_bf16 v[48:51], v[28:31], a[160:163], v[48:51]
    ds_read_b64_tr_b16 v[20:21], v2 offset:17408
    ds_read_b64_tr_b16 v[22:23], v2 offset:17920
    v_mfma_f32_16x16x32_bf16 v[36:39], v[24:27], a[164:167], v[36:39]
    s_add_u32 m0, s36, 65536
    s_cmp_eq_u32 s75, 0
    s_cselect_b32 s75, 0, 0x7ffffff0
    v_mfma_f32_16x16x32_bf16 v[52:55], v[28:31], a[164:167], v[52:55]
    buffer_load_dwordx4 v1, s[12:15], s57 offen lds
    v_or_b32 v132, s75, v12
    v_mfma_f32_16x16x32_bf16 v[40:43], v[24:27], a[168:171], v[40:43]
    buffer_load_dwordx4 v1, s[16:19], s57 offen offset:1024 lds
    v_or_b32 v130, s75, v130
    v_mfma_f32_16x16x32_bf16 v[56:59], v[28:31], a[168:171], v[56:59]
    s_add_u32 s75, s74, 589824
    buffer_store_dwordx2 v[152:153], v132, s[20:23], s74 offen sc1
    v_mfma_f32_16x16x32_bf16 v[44:47], v[24:27], a[172:175], v[44:47]
    buffer_store_dwordx2 v[154:155], v132, s[20:23], s75 offen sc1
    s_mov_b32 s74, 1179648
    v_mfma_f32_16x16x32_bf16 v[60:63], v[28:31], a[172:175], v[60:63]
    buffer_store_dword v148, v130, s[20:23], s74 offen sc1
    v_add_u32 v1, 128, v1
    s_waitcnt lgkmcnt(0)
    v_mfma_f32_16x16x32_bf16 v[32:35], v[16:19], a[176:179], v[32:35]
    ds_read_b64_tr_b16 v[24:25], v2 offset:24576
    ds_read_b64_tr_b16 v[26:27], v2 offset:25088
    v_mfma_f32_16x16x32_bf16 v[48:51], v[20:23], a[176:179], v[48:51]
    ds_read_b64_tr_b16 v[28:29], v2 offset:25600
    ds_read_b64_tr_b16 v[30:31], v2 offset:26112
    v_mfma_f32_16x16x32_bf16 v[36:39], v[16:19], a[180:183], v[36:39]
    s_add_u32 m0, s36, 0
    s_nop 0
    buffer_load_dwordx4 v1, s[12:15], s40 offen lds
    v_mfma_f32_16x16x32_bf16 v[52:55], v[20:23], a[180:183], v[52:55]
    buffer_load_dwordx4 v1, s[16:19], s40 offen offset:1024 lds
    v_mfma_f32_16x16x32_bf16 v[40:43], v[16:19], a[184:187], v[40:43]
    v_mfma_f32_16x16x32_bf16 v[56:59], v[20:23], a[184:187], v[56:59]
    v_mfma_f32_16x16x32_bf16 v[44:47], v[16:19], a[188:191], v[44:47]
    v_mfma_f32_16x16x32_bf16 v[60:63], v[20:23], a[188:191], v[60:63]
    s_waitcnt vmcnt(9) lgkmcnt(0)
    s_barrier
    v_mfma_f32_16x16x32_bf16 v[32:35], v[24:27], a[192:195], v[32:35]
    ds_read_b64_tr_b16 v[16:17], v2 offset:32768
    ds_read_b64_tr_b16 v[18:19], v2 offset:33280
    v_mfma_f32_16x16x32_bf16 v[48:51], v[28:31], a[192:195], v[48:51]
    ds_read_b64_tr_b16 v[20:21], v2 offset:33792
    ds_read_b64_tr_b16 v[22:23], v2 offset:34304
    v_mfma_f32_16x16x32_bf16 v[36:39], v[24:27], a[196:199], v[36:39]
    s_add_u32 m0, s36, 8192
    s_nop 0
    buffer_load_dwordx4 v1, s[12:15], s41 offen lds
    v_mfma_f32_16x16x32_bf16 v[52:55], v[28:31], a[196:199], v[52:55]
    buffer_load_dwordx4 v1, s[16:19], s41 offen offset:1024 lds
    v_mfma_f32_16x16x32_bf16 v[40:43], v[24:27], a[200:203], v[40:43]
    v_mfma_f32_16x16x32_bf16 v[56:59], v[28:31], a[200:203], v[56:59]
    v_mfma_f32_16x16x32_bf16 v[44:47], v[24:27], a[204:207], v[44:47]
    v_mfma_f32_16x16x32_bf16 v[60:63], v[28:31], a[204:207], v[60:63]
    s_waitcnt lgkmcnt(0)
    v_mfma_f32_16x16x32_bf16 v[32:35], v[16:19], a[208:211], v[32:35]
    ds_read_b64_tr_b16 v[24:25], v2 offset:40960
    ds_read_b64_tr_b16 v[26:27], v2 offset:41472
    v_mfma_f32_16x16x32_bf16 v[48:51], v[20:23], a[208:211], v[48:51]
    ds_read_b64_tr_b16 v[28:29], v2 offset:41984
    ds_read_b64_tr_b16 v[30:31], v2 offset:42496
    v_mfma_f32_16x16x32_bf16 v[36:39], v[16:19], a[212:215], v[36:39]
    s_add_u32 m0, s36, 16384
    s_nop 0
    buffer_load_dwordx4 v1, s[12:15], s42 offen lds
    v_mfma_f32_16x16x32_bf16 v[52:55], v[20:23], a[212:215], v[52:55]
    buffer_load_dwordx4 v1, s[16:19], s42 offen offset:1024 lds
    v_mfma_f32_16x16x32_bf16 v[40:43], v[16:19], a[216:219], v[40:43]
    v_mfma_f32_16x16x32_bf16 v[56:59], v[20:23], a[216:219], v[56:59]
    v_mfma_f32_16x16x32_bf16 v[44:47], v[16:19], a[220:223], v[44:47]
    v_mfma_f32_16x16x32_bf16 v[60:63], v[20:23], a[220:223], v[60:63]
    s_waitcnt lgkmcnt(0)
    v_mfma_f32_16x16x32_bf16 v[32:35], v[24:27], a[224:227], v[32:35]
    ds_read_b64_tr_b16 v[16:17], v2 offset:49152
    ds_read_b64_tr_b16 v[18:19], v2 offset:49664
    v_mfma_f32_16x16x32_bf16 v[48:51], v[28:31], a[224:227], v[48:51]
    ds_read_b64_tr_b16 v[20:21], v2 offset:50176
    ds_read_b64_tr_b16 v[22:23], v2 offset:50688
    v_mfma_f32_16x16x32_bf16 v[36:39], v[24:27], a[228:231], v[36:39]
    s_add_u32 m0, s36, 24576
    s_nop 0
    buffer_load_dwordx4 v1, s[12:15], s43 offen lds
    v_mfma_f32_16x16x32_bf16 v[52:55], v[28:31], a[228:231], v[52:55]
    buffer_load_dwordx4 v1, s[16:19], s43 offen offset:1024 lds
    v_mfma_f32_16x16x32_bf16 v[40:43], v[24:27], a[232:235], v[40:43]
    v_mfma_f32_16x16x32_bf16 v[56:59], v[28:31], a[232:235], v[56:59]
    v_mfma_f32_16x16x32_bf16 v[44:47], v[24:27], a[236:239], v[44:47]
    v_mfma_f32_16x16x32_bf16 v[60:63], v[28:31], a[236:239], v[60:63]
    s_waitcnt vmcnt(6) lgkmcnt(0)
    s_barrier
    v_mfma_f32_16x16x32_bf16 v[32:35], v[16:19], a[240:243], v[32:35]
    ds_read_b64_tr_b16 v[24:25], v2 offset:57344
    ds_read_b64_tr_b16 v[26:27], v2 offset:57856
    v_mfma_f32_16x16x32_bf16 v[48:51], v[20:23], a[240:243], v[48:51]
    ds_read_b64_tr_b16 v[28:29], v2 offset:58368
    ds_read_b64_tr_b16 v[30:31], v2 offset:58880
    v_mfma_f32_16x16x32_bf16 v[36:39], v[16:19], a[244:247], v[36:39]
    s_add_u32 m0, s36, 32768
    s_cmp_eq_u32 s5, 0
    s_cselect_b32 exec_lo, 1, 0
    s_mov_b32 exec_hi, 0
    buffer_atomic_add v15, off, s[68:71], 0 sc1
    s_mov_b64 exec, -1
    v_mfma_f32_16x16x32_bf16 v[52:55], v[20:23], a[244:247], v[52:55]
    buffer_load_dwordx4 v1, s[12:15], s44 offen lds
    buffer_load_dwordx4 v1, s[16:19], s44 offen offset:1024 lds
    v_mfma_f32_16x16x32_bf16 v[40:43], v[16:19], a[248:251], v[40:43]
    v_mfma_f32_16x16x32_bf16 v[56:59], v[20:23], a[248:251], v[56:59]
    v_mfma_f32_16x16x32_bf16 v[44:47], v[16:19], a[252:255], v[44:47]
    v_mfma_f32_16x16x32_bf16 v[60:63], v[20:23], a[252:255], v[60:63]
    s_waitcnt lgkmcnt(0)
    v_mfma_f32_16x16x32_bf16 v[32:35], v[24:27], v[224:227], v[32:35]
    ds_read_b64_tr_b16 v[16:17], v3 offset:0
    ds_read_b64_tr_b16 v[18:19], v3 offset:512
    v_mfma_f32_16x16x32_bf16 v[48:51], v[28:31], v[224:227], v[48:51]
    ds_read_b64_tr_b16 v[20:21], v3 offset:1024
    ds_read_b64_tr_b16 v[22:23], v3 offset:1536
    v_mfma_f32_16x16x32_bf16 v[36:39], v[24:27], v[228:231], v[36:39]
    s_add_u32 m0, s36, 40960
    s_nop 0
    buffer_load_dwordx4 v1, s[12:15], s45 offen lds
    v_mfma_f32_16x16x32_bf16 v[52:55], v[28:31], v[228:231], v[52:55]
    buffer_load_dwordx4 v1, s[16:19], s45 offen offset:1024 lds
    v_mfma_f32_16x16x32_bf16 v[40:43], v[24:27], v[232:235], v[40:43]
    v_mfma_f32_16x16x32_bf16 v[56:59], v[28:31], v[232:235], v[56:59]
    v_mfma_f32_16x16x32_bf16 v[44:47], v[24:27], v[236:239], v[44:47]
    v_mfma_f32_16x16x32_bf16 v[60:63], v[28:31], v[236:239], v[60:63]
    s_waitcnt lgkmcnt(0)
    v_mfma_f32_16x16x32_bf16 v[32:35], v[16:19], v[240:243], v[32:35]
    ds_read_b64_tr_b16 v[24:25], v2 offset:0
    ds_read_b64_tr_b16 v[26:27], v2 offset:512
    v_mfma_f32_16x16x32_bf16 v[48:51], v[20:23], v[240:243], v[48:51]
    ds_read_b64_tr_b16 v[28:29], v2 offset:1024
    ds_read_b64_tr_b16 v[30:31], v2 offset:1536
    v_mfma_f32_16x16x32_bf16 v[36:39], v[16:19], v[244:247], v[36:39]
    s_add_u32 m0, s36, 49152
    s_nop 0
    buffer_load_dwordx4 v1, s[12:15], s46 offen lds
    v_mfma_f32_16x16x32_bf16 v[52:55], v[20:23], v[244:247], v[52:55]
    buffer_load_dwordx4 v1, s[16:19], s46 offen offset:1024 lds
    v_mfma_f32_16x16x32_bf16 v[40:43], v[16:19], v[248:251], v[40:43]
    v_mfma_f32_16x16x32_bf16 v[56:59], v[20:23], v[248:251], v[56:59]
    v_mfma_f32_16x16x32_bf16 v[44:47], v[16:19], v[252:255], v[44:47]
    v_mfma_f32_16x16x32_bf16 v[60:63], v[20:23], v[252:255], v[60:63]
    s_mov_b32 s37, 4
L_recurrent_scan__spectral_fnet__swiglu_ffn__prompt_kernel_p1_7:
    s_waitcnt vmcnt(6) lgkmcnt(0)
    s_barrier
    v_mfma_f32_16x16x32_bf16 v[64:67], v[24:27], a[0:3], 0
    ds_read_b64_tr_b16 v[16:17], v2 offset:8192
    ds_read_b64_tr_b16 v[18:19], v2 offset:8704
    v_mfma_f32_16x16x32_bf16 v[80:83], v[28:31], a[0:3], 0
    ds_read_b64_tr_b16 v[20:21], v2 offset:9216
    ds_read_b64_tr_b16 v[22:23], v2 offset:9728
    v_mfma_f32_16x16x32_bf16 v[68:71], v[24:27], a[4:7], 0
    s_add_u32 m0, s36, 57344
    s_nop 0
    buffer_load_dwordx4 v1, s[12:15], s47 offen lds
    v_mfma_f32_16x16x32_bf16 v[84:87], v[28:31], a[4:7], 0
    buffer_load_dwordx4 v1, s[16:19], s47 offen offset:1024 lds
    v_mfma_f32_16x16x32_bf16 v[72:75], v[24:27], a[8:11], 0
    v_mfma_f32_16x16x32_bf16 v[88:91], v[28:31], a[8:11], 0
    v_mfma_f32_16x16x32_bf16 v[76:79], v[24:27], a[12:15], 0
    v_mfma_f32_16x16x32_bf16 v[92:95], v[28:31], a[12:15], 0
    s_waitcnt lgkmcnt(0)
    v_mfma_f32_16x16x32_bf16 v[64:67], v[16:19], a[16:19], v[64:67]
    ds_read_b64_tr_b16 v[24:25], v2 offset:16384
    ds_read_b64_tr_b16 v[26:27], v2 offset:16896
    v_mfma_f32_16x16x32_bf16 v[80:83], v[20:23], a[16:19], v[80:83]
    ds_read_b64_tr_b16 v[28:29], v2 offset:17408
    ds_read_b64_tr_b16 v[30:31], v2 offset:17920
    v_mfma_f32_16x16x32_bf16 v[68:71], v[16:19], a[20:23], v[68:71]
    s_add_u32 m0, s36, 65536
    v_mfma_f32_16x16x32_bf16 v[84:87], v[20:23], a[20:23], v[84:87]
    v_exp_f32 v96, -v32
    buffer_load_dwordx4 v1, s[12:15], s48 offen lds
    v_mfma_f32_16x16x32_bf16 v[72:75], v[16:19], a[24:27], v[72:75]
    v_exp_f32 v97, -v33
    v_mfma_f32_16x16x32_bf16 v[88:91], v[20:23], a[24:27], v[88:91]
    buffer_load_dwordx4 v1, s[16:19], s48 offen offset:1024 lds
    v_mfma_f32_16x16x32_bf16 v[76:79], v[16:19], a[28:31], v[76:79]
    v_exp_f32 v98, -v34
    v_mfma_f32_16x16x32_bf16 v[92:95], v[20:23], a[28:31], v[92:95]
    v_exp_f32 v99, -v35
    s_waitcnt lgkmcnt(0)
    v_mfma_f32_16x16x32_bf16 v[64:67], v[24:27], a[32:35], v[64:67]
    ds_read_b64_tr_b16 v[16:17], v2 offset:24576
    ds_read_b64_tr_b16 v[18:19], v2 offset:25088
    v_mfma_f32_16x16x32_bf16 v[80:83], v[28:31], a[32:35], v[80:83]
    ds_read_b64_tr_b16 v[20:21], v2 offset:25600
    ds_read_b64_tr_b16 v[22:23], v2 offset:26112
    v_mfma_f32_16x16x32_bf16 v[68:71], v[24:27], a[36:39], v[68:71]
    s_add_u32 m0, s36, 0
    v_mul_f32 v100, v32, v48
    v_mfma_f32_16x16x32_bf16 v[84:87], v[28:31], a[36:39], v[84:87]
    buffer_load_dwordx4 v1, s[12:15], s49 offen lds
    v_mul_f32 v101, v33, v49
    v_mfma_f32_16x16x32_bf16 v[72:75], v[24:27], a[40:43], v[72:75]
    buffer_load_dwordx4 v1, s[16:19], s49 offen offset:1024 lds
    v_mul_f32 v102, v34, v50
    v_mfma_f32_16x16x32_bf16 v[88:91], v[28:31], a[40:43], v[88:91]
    v_mul_f32 v103, v35, v51
    v_fma_f32 v96, v96, s39, s39
    v_mfma_f32_16x16x32_bf16 v[76:79], v[24:27], a[44:47], v[76:79]
    v_fma_f32 v97, v97, s39, s39
    v_fma_f32 v98, v98, s39, s39
    v_mfma_f32_16x16x32_bf16 v[92:95], v[28:31], a[44:47], v[92:95]
    s_waitcnt vmcnt(6) lgkmcnt(0)
    s_barrier
    v_mfma_f32_16x16x32_bf16 v[64:67], v[16:19], a[48:51], v[64:67]
    ds_read_b64_tr_b16 v[24:25], v2 offset:32768
    ds_read_b64_tr_b16 v[26:27], v2 offset:33280
    v_mfma_f32_16x16x32_bf16 v[80:83], v[20:23], a[48:51], v[80:83]
    ds_read_b64_tr_b16 v[28:29], v2 offset:33792
    ds_read_b64_tr_b16 v[30:31], v2 offset:34304
    v_mfma_f32_16x16x32_bf16 v[68:71], v[16:19], a[52:55], v[68:71]
    s_add_u32 m0, s36, 8192
    v_fma_f32 v99, v99, s39, s39
    v_mfma_f32_16x16x32_bf16 v[84:87], v[20:23], a[52:55], v[84:87]
    buffer_load_dwordx4 v1, s[12:15], s50 offen lds
    v_mfma_f32_16x16x32_bf16 v[72:75], v[16:19], a[56:59], v[72:75]
    v_rcp_f32 v96, v96
    buffer_load_dwordx4 v1, s[16:19], s50 offen offset:1024 lds
    v_mfma_f32_16x16x32_bf16 v[88:91], v[20:23], a[56:59], v[88:91]
    v_rcp_f32 v97, v97
    v_mfma_f32_16x16x32_bf16 v[76:79], v[16:19], a[60:63], v[76:79]
    v_rcp_f32 v98, v98
    v_mfma_f32_16x16x32_bf16 v[92:95], v[20:23], a[60:63], v[92:95]
    v_rcp_f32 v99, v99
    s_waitcnt lgkmcnt(0)
    v_mfma_f32_16x16x32_bf16 v[64:67], v[24:27], a[64:67], v[64:67]
    ds_read_b64_tr_b16 v[16:17], v2 offset:40960
    ds_read_b64_tr_b16 v[18:19], v2 offset:41472
    v_mfma_f32_16x16x32_bf16 v[80:83], v[28:31], a[64:67], v[80:83]
    ds_read_b64_tr_b16 v[20:21], v2 offset:41984
    ds_read_b64_tr_b16 v[22:23], v2 offset:42496
    v_mfma_f32_16x16x32_bf16 v[68:71], v[24:27], a[68:71], v[68:71]
    s_add_u32 m0, s36, 16384
    v_mul_f32 v100, v100, v96
    v_mfma_f32_16x16x32_bf16 v[84:87], v[28:31], a[68:71], v[84:87]
    buffer_load_dwordx4 v1, s[12:15], s51 offen lds
    v_mul_f32 v101, v101, v97
    v_mfma_f32_16x16x32_bf16 v[72:75], v[24:27], a[72:75], v[72:75]
    buffer_load_dwordx4 v1, s[16:19], s51 offen offset:1024 lds
    v_mul_f32 v102, v102, v98
    v_mfma_f32_16x16x32_bf16 v[88:91], v[28:31], a[72:75], v[88:91]
    v_mul_f32 v103, v103, v99
    v_cvt_pk_bf16_f32 v104, v100, v101
    v_mfma_f32_16x16x32_bf16 v[76:79], v[24:27], a[76:79], v[76:79]
    v_cvt_pk_bf16_f32 v105, v102, v103
    v_mfma_f32_16x16x32_bf16 v[92:95], v[28:31], a[76:79], v[92:95]
    s_waitcnt lgkmcnt(0)
    v_mfma_f32_16x16x32_bf16 v[64:67], v[16:19], a[80:83], v[64:67]
    ds_read_b64_tr_b16 v[24:25], v2 offset:49152
    ds_read_b64_tr_b16 v[26:27], v2 offset:49664
    v_mfma_f32_16x16x32_bf16 v[80:83], v[20:23], a[80:83], v[80:83]
    ds_read_b64_tr_b16 v[28:29], v2 offset:50176
    ds_read_b64_tr_b16 v[30:31], v2 offset:50688
    v_mfma_f32_16x16x32_bf16 v[68:71], v[16:19], a[84:87], v[68:71]
    s_add_u32 m0, s36, 24576
    ds_write_b64 v6, v[104:105] offset:0
    v_mfma_f32_16x16x32_bf16 v[84:87], v[20:23], a[84:87], v[84:87]
    buffer_load_dwordx4 v1, s[12:15], s52 offen lds
    v_mfma_f32_16x16x32_bf16 v[72:75], v[16:19], a[88:91], v[72:75]
    v_exp_f32 v108, -v36
    buffer_load_dwordx4 v1, s[16:19], s52 offen offset:1024 lds
    v_mfma_f32_16x16x32_bf16 v[88:91], v[20:23], a[88:91], v[88:91]
    v_exp_f32 v109, -v37
    v_mfma_f32_16x16x32_bf16 v[76:79], v[16:19], a[92:95], v[76:79]
    v_exp_f32 v110, -v38
    v_mfma_f32_16x16x32_bf16 v[92:95], v[20:23], a[92:95], v[92:95]
    s_waitcnt vmcnt(6) lgkmcnt(0)
    s_barrier
    v_mfma_f32_16x16x32_bf16 v[64:67], v[24:27], a[96:99], v[64:67]
    ds_read_b64_tr_b16 v[16:17], v2 offset:57344
    ds_read_b64_tr_b16 v[18:19], v2 offset:57856
    v_mfma_f32_16x16x32_bf16 v[80:83], v[28:31], a[96:99], v[80:83]
    ds_read_b64_tr_b16 v[20:21], v2 offset:58368
    ds_read_b64_tr_b16 v[22:23], v2 offset:58880
    v_mfma_f32_16x16x32_bf16 v[68:71], v[24:27], a[100:103], v[68:71]
    s_add_u32 m0, s36, 32768
    v_mfma_f32_16x16x32_bf16 v[84:87], v[28:31], a[100:103], v[84:87]
    v_exp_f32 v111, -v39
    buffer_load_dwordx4 v1, s[12:15], s53 offen lds
    v_mfma_f32_16x16x32_bf16 v[72:75], v[24:27], a[104:107], v[72:75]
    v_mul_f32 v112, v36, v52
    buffer_load_dwordx4 v1, s[16:19], s53 offen offset:1024 lds
    v_mfma_f32_16x16x32_bf16 v[88:91], v[28:31], a[104:107], v[88:91]
    v_mul_f32 v113, v37, v53
    v_mul_f32 v114, v38, v54
    v_mfma_f32_16x16x32_bf16 v[76:79], v[24:27], a[108:111], v[76:79]
    v_mul_f32 v115, v39, v55
    v_fma_f32 v108, v108, s39, s39
    v_mfma_f32_16x16x32_bf16 v[92:95], v[28:31], a[108:111], v[92:95]
    v_fma_f32 v109, v109, s39, s39
    s_waitcnt lgkmcnt(0)
    v_mfma_f32_16x16x32_bf16 v[64:67], v[16:19], a[112:115], v[64:67]
    ds_read_b64_tr_b16 v[24:25], v3 offset:0
    ds_read_b64_tr_b16 v[26:27], v3 offset:512
    v_mfma_f32_16x16x32_bf16 v[80:83], v[20:23], a[112:115], v[80:83]
    ds_read_b64_tr_b16 v[28:29], v3 offset:1024
    ds_read_b64_tr_b16 v[30:31], v3 offset:1536
    v_mfma_f32_16x16x32_bf16 v[68:71], v[16:19], a[116:119], v[68:71]
    s_add_u32 m0, s36, 40960
    v_fma_f32 v110, v110, s39, s39
    v_mfma_f32_16x16x32_bf16 v[84:87], v[20:23], a[116:119], v[84:87]
    buffer_load_dwordx4 v1, s[12:15], s54 offen lds
    v_fma_f32 v111, v111, s39, s39
    v_mfma_f32_16x16x32_bf16 v[72:75], v[16:19], a[120:123], v[72:75]
    buffer_load_dwordx4 v1, s[16:19], s54 offen offset:1024 lds
    v_mfma_f32_16x16x32_bf16 v[88:91], v[20:23], a[120:123], v[88:91]
    v_rcp_f32 v108, v108
    v_mfma_f32_16x16x32_bf16 v[76:79], v[16:19], a[124:127], v[76:79]
    v_rcp_f32 v109, v109
    v_mfma_f32_16x16x32_bf16 v[92:95], v[20:23], a[124:127], v[92:95]
    v_rcp_f32 v110, v110
    s_waitcnt lgkmcnt(0)
    v_mfma_f32_16x16x32_bf16 v[64:67], v[24:27], a[128:131], v[64:67]
    ds_read_b64_tr_b16 v[16:17], v2 offset:0
    ds_read_b64_tr_b16 v[18:19], v2 offset:512
    v_mfma_f32_16x16x32_bf16 v[80:83], v[28:31], a[128:131], v[80:83]
    ds_read_b64_tr_b16 v[20:21], v2 offset:1024
    ds_read_b64_tr_b16 v[22:23], v2 offset:1536
    v_mfma_f32_16x16x32_bf16 v[68:71], v[24:27], a[132:135], v[68:71]
    s_add_u32 m0, s36, 49152
    v_mfma_f32_16x16x32_bf16 v[84:87], v[28:31], a[132:135], v[84:87]
    v_rcp_f32 v111, v111
    buffer_load_dwordx4 v1, s[12:15], s55 offen lds
    v_mfma_f32_16x16x32_bf16 v[72:75], v[24:27], a[136:139], v[72:75]
    v_mul_f32 v112, v112, v108
    buffer_load_dwordx4 v1, s[16:19], s55 offen offset:1024 lds
    v_mfma_f32_16x16x32_bf16 v[88:91], v[28:31], a[136:139], v[88:91]
    v_mul_f32 v113, v113, v109
    v_mul_f32 v114, v114, v110
    v_mfma_f32_16x16x32_bf16 v[76:79], v[24:27], a[140:143], v[76:79]
    v_mul_f32 v115, v115, v111
    v_mfma_f32_16x16x32_bf16 v[92:95], v[28:31], a[140:143], v[92:95]
    s_waitcnt vmcnt(6) lgkmcnt(0)
    s_barrier
    v_mfma_f32_16x16x32_bf16 v[64:67], v[16:19], a[144:147], v[64:67]
    ds_read_b64_tr_b16 v[24:25], v2 offset:8192
    ds_read_b64_tr_b16 v[26:27], v2 offset:8704
    v_mfma_f32_16x16x32_bf16 v[80:83], v[20:23], a[144:147], v[80:83]
    ds_read_b64_tr_b16 v[28:29], v2 offset:9216
    ds_read_b64_tr_b16 v[30:31], v2 offset:9728
    v_mfma_f32_16x16x32_bf16 v[68:71], v[16:19], a[148:151], v[68:71]
    s_add_u32 m0, s36, 57344
    v_cvt_pk_bf16_f32 v116, v112, v113
    v_mfma_f32_16x16x32_bf16 v[84:87], v[20:23], a[148:151], v[84:87]
    buffer_load_dwordx4 v1, s[12:15], s56 offen lds
    v_cvt_pk_bf16_f32 v117, v114, v115
    v_mfma_f32_16x16x32_bf16 v[72:75], v[16:19], a[152:155], v[72:75]
    buffer_load_dwordx4 v1, s[16:19], s56 offen offset:1024 lds
    ds_write_b64 v6, v[116:117] offset:1024
    v_mfma_f32_16x16x32_bf16 v[88:91], v[20:23], a[152:155], v[88:91]
    v_exp_f32 v96, -v40
    v_mfma_f32_16x16x32_bf16 v[76:79], v[16:19], a[156:159], v[76:79]
    v_exp_f32 v97, -v41
    v_mfma_f32_16x16x32_bf16 v[92:95], v[20:23], a[156:159], v[92:95]
    v_exp_f32 v98, -v42
    s_waitcnt lgkmcnt(1)
    v_mfma_f32_16x16x32_bf16 v[64:67], v[24:27], a[160:163], v[64:67]
    ds_read_b64_tr_b16 v[16:17], v2 offset:16384
    ds_read_b64_tr_b16 v[18:19], v2 offset:16896
    v_mfma_f32_16x16x32_bf16 v[80:83], v[28:31], a[160:163], v[80:83]
    ds_read_b64_tr_b16 v[20:21], v2 offset:17408
    ds_read_b64_tr_b16 v[22:23], v2 offset:17920
    v_mfma_f32_16x16x32_bf16 v[68:71], v[24:27], a[164:167], v[68:71]
    s_add_u32 m0, s36, 65536
    v_mfma_f32_16x16x32_bf16 v[84:87], v[28:31], a[164:167], v[84:87]
    v_exp_f32 v99, -v43
    buffer_load_dwordx4 v1, s[12:15], s57 offen lds
    v_mfma_f32_16x16x32_bf16 v[72:75], v[24:27], a[168:171], v[72:75]
    v_mul_f32 v100, v40, v56
    buffer_load_dwordx4 v1, s[16:19], s57 offen offset:1024 lds
    v_mfma_f32_16x16x32_bf16 v[88:91], v[28:31], a[168:171], v[88:91]
    v_mul_f32 v101, v41, v57
    v_mul_f32 v102, v42, v58
    v_mfma_f32_16x16x32_bf16 v[76:79], v[24:27], a[172:175], v[76:79]
    v_mul_f32 v103, v43, v59
    v_mfma_f32_16x16x32_bf16 v[92:95], v[28:31], a[172:175], v[92:95]
    v_add_u32 v1, 128, v1
    s_waitcnt lgkmcnt(0)
    v_mfma_f32_16x16x32_bf16 v[64:67], v[16:19], a[176:179], v[64:67]
    ds_read_b64_tr_b16 v[24:25], v2 offset:24576
    ds_read_b64_tr_b16 v[26:27], v2 offset:25088
    v_mfma_f32_16x16x32_bf16 v[80:83], v[20:23], a[176:179], v[80:83]
    ds_read_b64_tr_b16 v[28:29], v2 offset:25600
    ds_read_b64_tr_b16 v[30:31], v2 offset:26112
    v_mfma_f32_16x16x32_bf16 v[68:71], v[16:19], a[180:183], v[68:71]
    s_add_u32 m0, s36, 0
    v_fma_f32 v96, v96, s39, s39
    v_mfma_f32_16x16x32_bf16 v[84:87], v[20:23], a[180:183], v[84:87]
    buffer_load_dwordx4 v1, s[12:15], s40 offen lds
    v_fma_f32 v97, v97, s39, s39
    v_mfma_f32_16x16x32_bf16 v[72:75], v[16:19], a[184:187], v[72:75]
    buffer_load_dwordx4 v1, s[16:19], s40 offen offset:1024 lds
    v_fma_f32 v98, v98, s39, s39
    v_mfma_f32_16x16x32_bf16 v[88:91], v[20:23], a[184:187], v[88:91]
    v_fma_f32 v99, v99, s39, s39
    v_mfma_f32_16x16x32_bf16 v[76:79], v[16:19], a[188:191], v[76:79]
    v_rcp_f32 v96, v96
    v_mfma_f32_16x16x32_bf16 v[92:95], v[20:23], a[188:191], v[92:95]
    v_rcp_f32 v97, v97
    s_waitcnt vmcnt(6) lgkmcnt(0)
    s_barrier
    v_mfma_f32_16x16x32_bf16 v[64:67], v[24:27], a[192:195], v[64:67]
    ds_read_b64_tr_b16 v[16:17], v2 offset:32768
    ds_read_b64_tr_b16 v[18:19], v2 offset:33280
    v_mfma_f32_16x16x32_bf16 v[80:83], v[28:31], a[192:195], v[80:83]
    ds_read_b64_tr_b16 v[20:21], v2 offset:33792
    ds_read_b64_tr_b16 v[22:23], v2 offset:34304
    v_mfma_f32_16x16x32_bf16 v[68:71], v[24:27], a[196:199], v[68:71]
    s_add_u32 m0, s36, 8192
    v_mfma_f32_16x16x32_bf16 v[84:87], v[28:31], a[196:199], v[84:87]
    v_rcp_f32 v98, v98
    buffer_load_dwordx4 v1, s[12:15], s41 offen lds
    v_mfma_f32_16x16x32_bf16 v[72:75], v[24:27], a[200:203], v[72:75]
    v_rcp_f32 v99, v99
    v_mfma_f32_16x16x32_bf16 v[88:91], v[28:31], a[200:203], v[88:91]
    buffer_load_dwordx4 v1, s[16:19], s41 offen offset:1024 lds
    v_mul_f32 v100, v100, v96
    v_mfma_f32_16x16x32_bf16 v[76:79], v[24:27], a[204:207], v[76:79]
    v_mul_f32 v101, v101, v97
    v_mul_f32 v102, v102, v98
    v_mfma_f32_16x16x32_bf16 v[92:95], v[28:31], a[204:207], v[92:95]
    s_waitcnt lgkmcnt(0)
    v_mfma_f32_16x16x32_bf16 v[64:67], v[16:19], a[208:211], v[64:67]
    ds_read_b64_tr_b16 v[24:25], v2 offset:40960
    ds_read_b64_tr_b16 v[26:27], v2 offset:41472
    v_mfma_f32_16x16x32_bf16 v[80:83], v[20:23], a[208:211], v[80:83]
    ds_read_b64_tr_b16 v[28:29], v2 offset:41984
    ds_read_b64_tr_b16 v[30:31], v2 offset:42496
    v_mfma_f32_16x16x32_bf16 v[68:71], v[16:19], a[212:215], v[68:71]
    s_add_u32 m0, s36, 16384
    v_mul_f32 v103, v103, v99
    v_mfma_f32_16x16x32_bf16 v[84:87], v[20:23], a[212:215], v[84:87]
    buffer_load_dwordx4 v1, s[12:15], s42 offen lds
    v_cvt_pk_bf16_f32 v104, v100, v101
    v_mfma_f32_16x16x32_bf16 v[72:75], v[16:19], a[216:219], v[72:75]
    buffer_load_dwordx4 v1, s[16:19], s42 offen offset:1024 lds
    v_cvt_pk_bf16_f32 v105, v102, v103
    v_mfma_f32_16x16x32_bf16 v[88:91], v[20:23], a[216:219], v[88:91]
    ds_write_b64 v6, v[104:105] offset:2048
    v_mfma_f32_16x16x32_bf16 v[76:79], v[16:19], a[220:223], v[76:79]
    v_exp_f32 v108, -v44
    v_mfma_f32_16x16x32_bf16 v[92:95], v[20:23], a[220:223], v[92:95]
    v_exp_f32 v109, -v45
    s_waitcnt lgkmcnt(1)
    v_mfma_f32_16x16x32_bf16 v[64:67], v[24:27], a[224:227], v[64:67]
    ds_read_b64_tr_b16 v[16:17], v2 offset:49152
    ds_read_b64_tr_b16 v[18:19], v2 offset:49664
    v_mfma_f32_16x16x32_bf16 v[80:83], v[28:31], a[224:227], v[80:83]
    ds_read_b64_tr_b16 v[20:21], v2 offset:50176
    ds_read_b64_tr_b16 v[22:23], v2 offset:50688
    v_mfma_f32_16x16x32_bf16 v[68:71], v[24:27], a[228:231], v[68:71]
    s_add_u32 m0, s36, 24576
    v_mfma_f32_16x16x32_bf16 v[84:87], v[28:31], a[228:231], v[84:87]
    v_exp_f32 v110, -v46
    buffer_load_dwordx4 v1, s[12:15], s43 offen lds
    v_mfma_f32_16x16x32_bf16 v[72:75], v[24:27], a[232:235], v[72:75]
    v_exp_f32 v111, -v47
    v_mfma_f32_16x16x32_bf16 v[88:91], v[28:31], a[232:235], v[88:91]
    buffer_load_dwordx4 v1, s[16:19], s43 offen offset:1024 lds
    v_mul_f32 v112, v44, v60
    v_mfma_f32_16x16x32_bf16 v[76:79], v[24:27], a[236:239], v[76:79]
    v_mul_f32 v113, v45, v61
    v_mfma_f32_16x16x32_bf16 v[92:95], v[28:31], a[236:239], v[92:95]
    s_waitcnt vmcnt(6) lgkmcnt(0)
    s_barrier
    v_mfma_f32_16x16x32_bf16 v[64:67], v[16:19], a[240:243], v[64:67]
    ds_read_b64_tr_b16 v[24:25], v2 offset:57344
    ds_read_b64_tr_b16 v[26:27], v2 offset:57856
    v_mfma_f32_16x16x32_bf16 v[80:83], v[20:23], a[240:243], v[80:83]
    ds_read_b64_tr_b16 v[28:29], v2 offset:58368
    ds_read_b64_tr_b16 v[30:31], v2 offset:58880
    v_mfma_f32_16x16x32_bf16 v[68:71], v[16:19], a[244:247], v[68:71]
    s_add_u32 m0, s36, 32768
    v_mul_f32 v114, v46, v62
    v_mfma_f32_16x16x32_bf16 v[84:87], v[20:23], a[244:247], v[84:87]
    buffer_load_dwordx4 v1, s[12:15], s44 offen lds
    v_mul_f32 v115, v47, v63
    v_mfma_f32_16x16x32_bf16 v[72:75], v[16:19], a[248:251], v[72:75]
    buffer_load_dwordx4 v1, s[16:19], s44 offen offset:1024 lds
    v_fma_f32 v108, v108, s39, s39
    v_mfma_f32_16x16x32_bf16 v[88:91], v[20:23], a[248:251], v[88:91]
    v_fma_f32 v109, v109, s39, s39
    v_fma_f32 v110, v110, s39, s39
    v_mfma_f32_16x16x32_bf16 v[76:79], v[16:19], a[252:255], v[76:79]
    v_fma_f32 v111, v111, s39, s39
    v_mfma_f32_16x16x32_bf16 v[92:95], v[20:23], a[252:255], v[92:95]
    v_rcp_f32 v108, v108
    s_waitcnt lgkmcnt(0)
    v_mfma_f32_16x16x32_bf16 v[64:67], v[24:27], v[224:227], v[64:67]
    ds_read_b64_tr_b16 v[16:17], v3 offset:0
    ds_read_b64_tr_b16 v[18:19], v3 offset:512
    v_mfma_f32_16x16x32_bf16 v[80:83], v[28:31], v[224:227], v[80:83]
    ds_read_b64_tr_b16 v[20:21], v3 offset:1024
    ds_read_b64_tr_b16 v[22:23], v3 offset:1536
    v_mfma_f32_16x16x32_bf16 v[68:71], v[24:27], v[228:231], v[68:71]
    s_add_u32 m0, s36, 40960
    v_mfma_f32_16x16x32_bf16 v[84:87], v[28:31], v[228:231], v[84:87]
    v_rcp_f32 v109, v109
    buffer_load_dwordx4 v1, s[12:15], s45 offen lds
    v_mfma_f32_16x16x32_bf16 v[72:75], v[24:27], v[232:235], v[72:75]
    v_rcp_f32 v110, v110
    v_mfma_f32_16x16x32_bf16 v[88:91], v[28:31], v[232:235], v[88:91]
    buffer_load_dwordx4 v1, s[16:19], s45 offen offset:1024 lds
    v_mfma_f32_16x16x32_bf16 v[76:79], v[24:27], v[236:239], v[76:79]
    v_rcp_f32 v111, v111
    v_mul_f32 v112, v112, v108
    v_mfma_f32_16x16x32_bf16 v[92:95], v[28:31], v[236:239], v[92:95]
    s_waitcnt lgkmcnt(0)
    v_mfma_f32_16x16x32_bf16 v[64:67], v[16:19], v[240:243], v[64:67]
    ds_read_b64_tr_b16 v[24:25], v2 offset:0
    ds_read_b64_tr_b16 v[26:27], v2 offset:512
    v_mfma_f32_16x16x32_bf16 v[80:83], v[20:23], v[240:243], v[80:83]
    ds_read_b64_tr_b16 v[28:29], v2 offset:1024
    ds_read_b64_tr_b16 v[30:31], v2 offset:1536
    v_mfma_f32_16x16x32_bf16 v[68:71], v[16:19], v[244:247], v[68:71]
    s_add_u32 m0, s36, 49152
    v_mul_f32 v113, v113, v109
    v_mfma_f32_16x16x32_bf16 v[84:87], v[20:23], v[244:247], v[84:87]
    buffer_load_dwordx4 v1, s[12:15], s46 offen lds
    v_mul_f32 v114, v114, v110
    v_mfma_f32_16x16x32_bf16 v[72:75], v[16:19], v[248:251], v[72:75]
    buffer_load_dwordx4 v1, s[16:19], s46 offen offset:1024 lds
    v_mul_f32 v115, v115, v111
    v_mfma_f32_16x16x32_bf16 v[88:91], v[20:23], v[248:251], v[88:91]
    v_cvt_pk_bf16_f32 v116, v112, v113
    v_cvt_pk_bf16_f32 v117, v114, v115
    v_mfma_f32_16x16x32_bf16 v[76:79], v[16:19], v[252:255], v[76:79]
    ds_write_b64 v6, v[116:117] offset:3072
    v_add_u32 v6, 8192, v6
    v_mfma_f32_16x16x32_bf16 v[92:95], v[20:23], v[252:255], v[92:95]
    s_waitcnt vmcnt(6) lgkmcnt(0)
    s_barrier
    v_mfma_f32_16x16x32_bf16 v[32:35], v[24:27], a[0:3], 0
    ds_read_b64_tr_b16 v[16:17], v2 offset:8192
    ds_read_b64_tr_b16 v[18:19], v2 offset:8704
    v_mfma_f32_16x16x32_bf16 v[48:51], v[28:31], a[0:3], 0
    ds_read_b64_tr_b16 v[20:21], v2 offset:9216
    ds_read_b64_tr_b16 v[22:23], v2 offset:9728
    v_mfma_f32_16x16x32_bf16 v[36:39], v[24:27], a[4:7], 0
    s_add_u32 m0, s36, 57344
    s_nop 0
    buffer_load_dwordx4 v1, s[12:15], s47 offen lds
    v_mfma_f32_16x16x32_bf16 v[52:55], v[28:31], a[4:7], 0
    buffer_load_dwordx4 v1, s[16:19], s47 offen offset:1024 lds
    v_mfma_f32_16x16x32_bf16 v[40:43], v[24:27], a[8:11], 0
    v_mfma_f32_16x16x32_bf16 v[56:59], v[28:31], a[8:11], 0
    v_mfma_f32_16x16x32_bf16 v[44:47], v[24:27], a[12:15], 0
    v_mfma_f32_16x16x32_bf16 v[60:63], v[28:31], a[12:15], 0
    s_waitcnt lgkmcnt(0)
    v_mfma_f32_16x16x32_bf16 v[32:35], v[16:19], a[16:19], v[32:35]
    ds_read_b64_tr_b16 v[24:25], v2 offset:16384
    ds_read_b64_tr_b16 v[26:27], v2 offset:16896
    v_mfma_f32_16x16x32_bf16 v[48:51], v[20:23], a[16:19], v[48:51]
    ds_read_b64_tr_b16 v[28:29], v2 offset:17408
    ds_read_b64_tr_b16 v[30:31], v2 offset:17920
    v_mfma_f32_16x16x32_bf16 v[36:39], v[16:19], a[20:23], v[36:39]
    s_add_u32 m0, s36, 65536
    v_mfma_f32_16x16x32_bf16 v[52:55], v[20:23], a[20:23], v[52:55]
    v_exp_f32 v96, -v64
    buffer_load_dwordx4 v1, s[12:15], s48 offen lds
    v_mfma_f32_16x16x32_bf16 v[40:43], v[16:19], a[24:27], v[40:43]
    v_exp_f32 v97, -v65
    v_mfma_f32_16x16x32_bf16 v[56:59], v[20:23], a[24:27], v[56:59]
    buffer_load_dwordx4 v1, s[16:19], s48 offen offset:1024 lds
    v_mfma_f32_16x16x32_bf16 v[44:47], v[16:19], a[28:31], v[44:47]
    v_exp_f32 v98, -v66
    v_mfma_f32_16x16x32_bf16 v[60:63], v[20:23], a[28:31], v[60:63]
    v_exp_f32 v99, -v67
    s_waitcnt lgkmcnt(0)
    v_mfma_f32_16x16x32_bf16 v[32:35], v[24:27], a[32:35], v[32:35]
    ds_read_b64_tr_b16 v[16:17], v2 offset:24576
    ds_read_b64_tr_b16 v[18:19], v2 offset:25088
    v_mfma_f32_16x16x32_bf16 v[48:51], v[28:31], a[32:35], v[48:51]
    ds_read_b64_tr_b16 v[20:21], v2 offset:25600
    ds_read_b64_tr_b16 v[22:23], v2 offset:26112
    v_mfma_f32_16x16x32_bf16 v[36:39], v[24:27], a[36:39], v[36:39]
    s_add_u32 m0, s36, 0
    v_mul_f32 v100, v64, v80
    v_mfma_f32_16x16x32_bf16 v[52:55], v[28:31], a[36:39], v[52:55]
    buffer_load_dwordx4 v1, s[12:15], s49 offen lds
    v_mul_f32 v101, v65, v81
    v_mfma_f32_16x16x32_bf16 v[40:43], v[24:27], a[40:43], v[40:43]
    buffer_load_dwordx4 v1, s[16:19], s49 offen offset:1024 lds
    v_mul_f32 v102, v66, v82
    v_mfma_f32_16x16x32_bf16 v[56:59], v[28:31], a[40:43], v[56:59]
    v_mul_f32 v103, v67, v83
    v_fma_f32 v96, v96, s39, s39
    v_mfma_f32_16x16x32_bf16 v[44:47], v[24:27], a[44:47], v[44:47]
    v_fma_f32 v97, v97, s39, s39
    v_fma_f32 v98, v98, s39, s39
    v_mfma_f32_16x16x32_bf16 v[60:63], v[28:31], a[44:47], v[60:63]
    s_waitcnt vmcnt(6) lgkmcnt(0)
    s_barrier
    v_mfma_f32_16x16x32_bf16 v[32:35], v[16:19], a[48:51], v[32:35]
    ds_read_b64_tr_b16 v[24:25], v2 offset:32768
    ds_read_b64_tr_b16 v[26:27], v2 offset:33280
    v_mfma_f32_16x16x32_bf16 v[48:51], v[20:23], a[48:51], v[48:51]
    ds_read_b64_tr_b16 v[28:29], v2 offset:33792
    ds_read_b64_tr_b16 v[30:31], v2 offset:34304
    v_mfma_f32_16x16x32_bf16 v[36:39], v[16:19], a[52:55], v[36:39]
    s_add_u32 m0, s36, 8192
    v_fma_f32 v99, v99, s39, s39
    v_mfma_f32_16x16x32_bf16 v[52:55], v[20:23], a[52:55], v[52:55]
    buffer_load_dwordx4 v1, s[12:15], s50 offen lds
    v_mfma_f32_16x16x32_bf16 v[40:43], v[16:19], a[56:59], v[40:43]
    v_rcp_f32 v96, v96
    buffer_load_dwordx4 v1, s[16:19], s50 offen offset:1024 lds
    v_mfma_f32_16x16x32_bf16 v[56:59], v[20:23], a[56:59], v[56:59]
    v_rcp_f32 v97, v97
    v_mfma_f32_16x16x32_bf16 v[44:47], v[16:19], a[60:63], v[44:47]
    v_rcp_f32 v98, v98
    v_mfma_f32_16x16x32_bf16 v[60:63], v[20:23], a[60:63], v[60:63]
    v_rcp_f32 v99, v99
    s_waitcnt lgkmcnt(0)
    v_mfma_f32_16x16x32_bf16 v[32:35], v[24:27], a[64:67], v[32:35]
    ds_read_b64_tr_b16 v[16:17], v2 offset:40960
    ds_read_b64_tr_b16 v[18:19], v2 offset:41472
    v_mfma_f32_16x16x32_bf16 v[48:51], v[28:31], a[64:67], v[48:51]
    ds_read_b64_tr_b16 v[20:21], v2 offset:41984
    ds_read_b64_tr_b16 v[22:23], v2 offset:42496
    v_mfma_f32_16x16x32_bf16 v[36:39], v[24:27], a[68:71], v[36:39]
    s_add_u32 m0, s36, 16384
    v_mul_f32 v100, v100, v96
    v_mfma_f32_16x16x32_bf16 v[52:55], v[28:31], a[68:71], v[52:55]
    buffer_load_dwordx4 v1, s[12:15], s51 offen lds
    v_mul_f32 v101, v101, v97
    v_mfma_f32_16x16x32_bf16 v[40:43], v[24:27], a[72:75], v[40:43]
    buffer_load_dwordx4 v1, s[16:19], s51 offen offset:1024 lds
    v_mul_f32 v102, v102, v98
    v_mfma_f32_16x16x32_bf16 v[56:59], v[28:31], a[72:75], v[56:59]
    v_mul_f32 v103, v103, v99
    v_cvt_pk_bf16_f32 v104, v100, v101
    v_mfma_f32_16x16x32_bf16 v[44:47], v[24:27], a[76:79], v[44:47]
    v_cvt_pk_bf16_f32 v105, v102, v103
    v_mfma_f32_16x16x32_bf16 v[60:63], v[28:31], a[76:79], v[60:63]
    s_waitcnt lgkmcnt(0)
    v_mfma_f32_16x16x32_bf16 v[32:35], v[16:19], a[80:83], v[32:35]
    ds_read_b64_tr_b16 v[24:25], v2 offset:49152
    ds_read_b64_tr_b16 v[26:27], v2 offset:49664
    v_mfma_f32_16x16x32_bf16 v[48:51], v[20:23], a[80:83], v[48:51]
    ds_read_b64_tr_b16 v[28:29], v2 offset:50176
    ds_read_b64_tr_b16 v[30:31], v2 offset:50688
    v_mfma_f32_16x16x32_bf16 v[36:39], v[16:19], a[84:87], v[36:39]
    s_add_u32 m0, s36, 24576
    ds_write_b64 v6, v[104:105] offset:0
    v_mfma_f32_16x16x32_bf16 v[52:55], v[20:23], a[84:87], v[52:55]
    buffer_load_dwordx4 v1, s[12:15], s52 offen lds
    v_mfma_f32_16x16x32_bf16 v[40:43], v[16:19], a[88:91], v[40:43]
    v_exp_f32 v108, -v68
    buffer_load_dwordx4 v1, s[16:19], s52 offen offset:1024 lds
    v_mfma_f32_16x16x32_bf16 v[56:59], v[20:23], a[88:91], v[56:59]
    v_exp_f32 v109, -v69
    v_mfma_f32_16x16x32_bf16 v[44:47], v[16:19], a[92:95], v[44:47]
    v_exp_f32 v110, -v70
    v_mfma_f32_16x16x32_bf16 v[60:63], v[20:23], a[92:95], v[60:63]
    s_waitcnt vmcnt(6) lgkmcnt(0)
    s_barrier
    v_mfma_f32_16x16x32_bf16 v[32:35], v[24:27], a[96:99], v[32:35]
    ds_read_b64_tr_b16 v[16:17], v2 offset:57344
    ds_read_b64_tr_b16 v[18:19], v2 offset:57856
    v_mfma_f32_16x16x32_bf16 v[48:51], v[28:31], a[96:99], v[48:51]
    ds_read_b64_tr_b16 v[20:21], v2 offset:58368
    ds_read_b64_tr_b16 v[22:23], v2 offset:58880
    v_mfma_f32_16x16x32_bf16 v[36:39], v[24:27], a[100:103], v[36:39]
    s_add_u32 m0, s36, 32768
    v_mfma_f32_16x16x32_bf16 v[52:55], v[28:31], a[100:103], v[52:55]
    v_exp_f32 v111, -v71
    buffer_load_dwordx4 v1, s[12:15], s53 offen lds
    v_mfma_f32_16x16x32_bf16 v[40:43], v[24:27], a[104:107], v[40:43]
    v_mul_f32 v112, v68, v84
    buffer_load_dwordx4 v1, s[16:19], s53 offen offset:1024 lds
    v_mfma_f32_16x16x32_bf16 v[56:59], v[28:31], a[104:107], v[56:59]
    v_mul_f32 v113, v69, v85
    v_mul_f32 v114, v70, v86
    v_mfma_f32_16x16x32_bf16 v[44:47], v[24:27], a[108:111], v[44:47]
    v_mul_f32 v115, v71, v87
    v_fma_f32 v108, v108, s39, s39
    v_mfma_f32_16x16x32_bf16 v[60:63], v[28:31], a[108:111], v[60:63]
    v_fma_f32 v109, v109, s39, s39
    s_waitcnt lgkmcnt(0)
    v_mfma_f32_16x16x32_bf16 v[32:35], v[16:19], a[112:115], v[32:35]
    ds_read_b64_tr_b16 v[24:25], v3 offset:0
    ds_read_b64_tr_b16 v[26:27], v3 offset:512
    v_mfma_f32_16x16x32_bf16 v[48:51], v[20:23], a[112:115], v[48:51]
    ds_read_b64_tr_b16 v[28:29], v3 offset:1024
    ds_read_b64_tr_b16 v[30:31], v3 offset:1536
    v_mfma_f32_16x16x32_bf16 v[36:39], v[16:19], a[116:119], v[36:39]
    s_add_u32 m0, s36, 40960
    v_fma_f32 v110, v110, s39, s39
    v_mfma_f32_16x16x32_bf16 v[52:55], v[20:23], a[116:119], v[52:55]
    buffer_load_dwordx4 v1, s[12:15], s54 offen lds
    v_fma_f32 v111, v111, s39, s39
    v_mfma_f32_16x16x32_bf16 v[40:43], v[16:19], a[120:123], v[40:43]
    buffer_load_dwordx4 v1, s[16:19], s54 offen offset:1024 lds
    v_mfma_f32_16x16x32_bf16 v[56:59], v[20:23], a[120:123], v[56:59]
    v_rcp_f32 v108, v108
    v_mfma_f32_16x16x32_bf16 v[44:47], v[16:19], a[124:127], v[44:47]
    v_rcp_f32 v109, v109
    v_mfma_f32_16x16x32_bf16 v[60:63], v[20:23], a[124:127], v[60:63]
    v_rcp_f32 v110, v110
    s_waitcnt lgkmcnt(0)
    v_mfma_f32_16x16x32_bf16 v[32:35], v[24:27], a[128:131], v[32:35]
    ds_read_b64_tr_b16 v[16:17], v2 offset:0
    ds_read_b64_tr_b16 v[18:19], v2 offset:512
    v_mfma_f32_16x16x32_bf16 v[48:51], v[28:31], a[128:131], v[48:51]
    ds_read_b64_tr_b16 v[20:21], v2 offset:1024
    ds_read_b64_tr_b16 v[22:23], v2 offset:1536
    v_mfma_f32_16x16x32_bf16 v[36:39], v[24:27], a[132:135], v[36:39]
    s_add_u32 m0, s36, 49152
    v_mfma_f32_16x16x32_bf16 v[52:55], v[28:31], a[132:135], v[52:55]
    v_rcp_f32 v111, v111
    buffer_load_dwordx4 v1, s[12:15], s55 offen lds
    v_mfma_f32_16x16x32_bf16 v[40:43], v[24:27], a[136:139], v[40:43]
    v_mul_f32 v112, v112, v108
    buffer_load_dwordx4 v1, s[16:19], s55 offen offset:1024 lds
    v_mfma_f32_16x16x32_bf16 v[56:59], v[28:31], a[136:139], v[56:59]
    v_mul_f32 v113, v113, v109
    v_mul_f32 v114, v114, v110
    v_mfma_f32_16x16x32_bf16 v[44:47], v[24:27], a[140:143], v[44:47]
    v_mul_f32 v115, v115, v111
    v_mfma_f32_16x16x32_bf16 v[60:63], v[28:31], a[140:143], v[60:63]
    s_waitcnt vmcnt(6) lgkmcnt(0)
    s_barrier
    v_mfma_f32_16x16x32_bf16 v[32:35], v[16:19], a[144:147], v[32:35]
    ds_read_b64_tr_b16 v[24:25], v2 offset:8192
    ds_read_b64_tr_b16 v[26:27], v2 offset:8704
    v_mfma_f32_16x16x32_bf16 v[48:51], v[20:23], a[144:147], v[48:51]
    ds_read_b64_tr_b16 v[28:29], v2 offset:9216
    ds_read_b64_tr_b16 v[30:31], v2 offset:9728
    v_mfma_f32_16x16x32_bf16 v[36:39], v[16:19], a[148:151], v[36:39]
    s_add_u32 m0, s36, 57344
    v_cvt_pk_bf16_f32 v116, v112, v113
    v_mfma_f32_16x16x32_bf16 v[52:55], v[20:23], a[148:151], v[52:55]
    buffer_load_dwordx4 v1, s[12:15], s56 offen lds
    v_cvt_pk_bf16_f32 v117, v114, v115
    v_mfma_f32_16x16x32_bf16 v[40:43], v[16:19], a[152:155], v[40:43]
    buffer_load_dwordx4 v1, s[16:19], s56 offen offset:1024 lds
    ds_write_b64 v6, v[116:117] offset:1024
    v_mfma_f32_16x16x32_bf16 v[56:59], v[20:23], a[152:155], v[56:59]
    v_exp_f32 v96, -v72
    v_mfma_f32_16x16x32_bf16 v[44:47], v[16:19], a[156:159], v[44:47]
    v_exp_f32 v97, -v73
    v_mfma_f32_16x16x32_bf16 v[60:63], v[20:23], a[156:159], v[60:63]
    v_exp_f32 v98, -v74
    s_waitcnt lgkmcnt(1)
    v_mfma_f32_16x16x32_bf16 v[32:35], v[24:27], a[160:163], v[32:35]
    ds_read_b64_tr_b16 v[16:17], v2 offset:16384
    ds_read_b64_tr_b16 v[18:19], v2 offset:16896
    v_mfma_f32_16x16x32_bf16 v[48:51], v[28:31], a[160:163], v[48:51]
    ds_read_b64_tr_b16 v[20:21], v2 offset:17408
    ds_read_b64_tr_b16 v[22:23], v2 offset:17920
    v_mfma_f32_16x16x32_bf16 v[36:39], v[24:27], a[164:167], v[36:39]
    s_add_u32 m0, s36, 65536
    v_mfma_f32_16x16x32_bf16 v[52:55], v[28:31], a[164:167], v[52:55]
    v_exp_f32 v99, -v75
    buffer_load_dwordx4 v1, s[12:15], s57 offen lds
    v_mfma_f32_16x16x32_bf16 v[40:43], v[24:27], a[168:171], v[40:43]
    v_mul_f32 v100, v72, v88
    buffer_load_dwordx4 v1, s[16:19], s57 offen offset:1024 lds
    v_mfma_f32_16x16x32_bf16 v[56:59], v[28:31], a[168:171], v[56:59]
    v_mul_f32 v101, v73, v89
    v_mul_f32 v102, v74, v90
    v_mfma_f32_16x16x32_bf16 v[44:47], v[24:27], a[172:175], v[44:47]
    v_mul_f32 v103, v75, v91
    v_mfma_f32_16x16x32_bf16 v[60:63], v[28:31], a[172:175], v[60:63]
    s_cmp_lg_u32 s37, 1
    v_add_u32 v1, 128, v1
    s_cbranch_scc1 L_recurrent_scan__spectral_fnet__swiglu_ffn__prompt_kernel_sw_3
    v_mov_b32 v1, v10
    s_mov_b32 s12, s24
    s_mov_b32 s13, s25
    s_mov_b32 s14, 5308416
    s_add_u32 s16, s24, 35840
    s_addc_u32 s17, s25, 0
    s_mov_b32 s18, 5308416
    s_mov_b32 s40, 0
    s_mov_b32 s41, 73728
    s_mov_b32 s42, 147456
    s_mov_b32 s43, 221184
    s_mov_b32 s44, 294912
    s_mov_b32 s45, 368640
    s_mov_b32 s46, 442368
    s_mov_b32 s47, 516096
    s_mov_b32 s48, 589824
L_recurrent_scan__spectral_fnet__swiglu_ffn__prompt_kernel_sw_3:
    s_waitcnt lgkmcnt(0)
    v_mfma_f32_16x16x32_bf16 v[32:35], v[16:19], a[176:179], v[32:35]
    ds_read_b64_tr_b16 v[24:25], v2 offset:24576
    ds_read_b64_tr_b16 v[26:27], v2 offset:25088
    v_mfma_f32_16x16x32_bf16 v[48:51], v[20:23], a[176:179], v[48:51]
    ds_read_b64_tr_b16 v[28:29], v2 offset:25600
    ds_read_b64_tr_b16 v[30:31], v2 offset:26112
    v_mfma_f32_16x16x32_bf16 v[36:39], v[16:19], a[180:183], v[36:39]
    s_add_u32 m0, s36, 0
    v_fma_f32 v96, v96, s39, s39
    v_mfma_f32_16x16x32_bf16 v[52:55], v[20:23], a[180:183], v[52:55]
    buffer_load_dwordx4 v1, s[12:15], s40 offen lds
    v_fma_f32 v97, v97, s39, s39
    v_mfma_f32_16x16x32_bf16 v[40:43], v[16:19], a[184:187], v[40:43]
    buffer_load_dwordx4 v1, s[16:19], s40 offen offset:1024 lds
    v_fma_f32 v98, v98, s39, s39
    v_mfma_f32_16x16x32_bf16 v[56:59], v[20:23], a[184:187], v[56:59]
    v_fma_f32 v99, v99, s39, s39
    v_mfma_f32_16x16x32_bf16 v[44:47], v[16:19], a[188:191], v[44:47]
    v_rcp_f32 v96, v96
    v_mfma_f32_16x16x32_bf16 v[60:63], v[20:23], a[188:191], v[60:63]
    v_rcp_f32 v97, v97
    s_waitcnt vmcnt(6) lgkmcnt(0)
    s_barrier
    v_mfma_f32_16x16x32_bf16 v[32:35], v[24:27], a[192:195], v[32:35]
    ds_read_b64_tr_b16 v[16:17], v2 offset:32768
    ds_read_b64_tr_b16 v[18:19], v2 offset:33280
    v_mfma_f32_16x16x32_bf16 v[48:51], v[28:31], a[192:195], v[48:51]
    ds_read_b64_tr_b16 v[20:21], v2 offset:33792
    ds_read_b64_tr_b16 v[22:23], v2 offset:34304
    v_mfma_f32_16x16x32_bf16 v[36:39], v[24:27], a[196:199], v[36:39]
    s_add_u32 m0, s36, 8192
    v_mfma_f32_16x16x32_bf16 v[52:55], v[28:31], a[196:199], v[52:55]
    v_rcp_f32 v98, v98
    buffer_load_dwordx4 v1, s[12:15], s41 offen lds
    v_mfma_f32_16x16x32_bf16 v[40:43], v[24:27], a[200:203], v[40:43]
    v_rcp_f32 v99, v99
    v_mfma_f32_16x16x32_bf16 v[56:59], v[28:31], a[200:203], v[56:59]
    buffer_load_dwordx4 v1, s[16:19], s41 offen offset:1024 lds
    v_mul_f32 v100, v100, v96
    v_mfma_f32_16x16x32_bf16 v[44:47], v[24:27], a[204:207], v[44:47]
    v_mul_f32 v101, v101, v97
    v_mul_f32 v102, v102, v98
    v_mfma_f32_16x16x32_bf16 v[60:63], v[28:31], a[204:207], v[60:63]
    s_waitcnt lgkmcnt(0)
    v_mfma_f32_16x16x32_bf16 v[32:35], v[16:19], a[208:211], v[32:35]
    ds_read_b64_tr_b16 v[24:25], v2 offset:40960
    ds_read_b64_tr_b16 v[26:27], v2 offset:41472
    v_mfma_f32_16x16x32_bf16 v[48:51], v[20:23], a[208:211], v[48:51]
    ds_read_b64_tr_b16 v[28:29], v2 offset:41984
    ds_read_b64_tr_b16 v[30:31], v2 offset:42496
    v_mfma_f32_16x16x32_bf16 v[36:39], v[16:19], a[212:215], v[36:39]
    s_add_u32 m0, s36, 16384
    v_mul_f32 v103, v103, v99
    v_mfma_f32_16x16x32_bf16 v[52:55], v[20:23], a[212:215], v[52:55]
    buffer_load_dwordx4 v1, s[12:15], s42 offen lds
    v_cvt_pk_bf16_f32 v104, v100, v101
    v_mfma_f32_16x16x32_bf16 v[40:43], v[16:19], a[216:219], v[40:43]
    buffer_load_dwordx4 v1, s[16:19], s42 offen offset:1024 lds
    v_cvt_pk_bf16_f32 v105, v102, v103
    v_mfma_f32_16x16x32_bf16 v[56:59], v[20:23], a[216:219], v[56:59]
    ds_write_b64 v6, v[104:105] offset:2048
    v_mfma_f32_16x16x32_bf16 v[44:47], v[16:19], a[220:223], v[44:47]
    v_exp_f32 v108, -v76
    v_mfma_f32_16x16x32_bf16 v[60:63], v[20:23], a[220:223], v[60:63]
    v_exp_f32 v109, -v77
    s_waitcnt lgkmcnt(1)
    v_mfma_f32_16x16x32_bf16 v[32:35], v[24:27], a[224:227], v[32:35]
    ds_read_b64_tr_b16 v[16:17], v2 offset:49152
    ds_read_b64_tr_b16 v[18:19], v2 offset:49664
    v_mfma_f32_16x16x32_bf16 v[48:51], v[28:31], a[224:227], v[48:51]
    ds_read_b64_tr_b16 v[20:21], v2 offset:50176
    ds_read_b64_tr_b16 v[22:23], v2 offset:50688
    v_mfma_f32_16x16x32_bf16 v[36:39], v[24:27], a[228:231], v[36:39]
    s_add_u32 m0, s36, 24576
    v_mfma_f32_16x16x32_bf16 v[52:55], v[28:31], a[228:231], v[52:55]
    v_exp_f32 v110, -v78
    buffer_load_dwordx4 v1, s[12:15], s43 offen lds
    v_mfma_f32_16x16x32_bf16 v[40:43], v[24:27], a[232:235], v[40:43]
    v_exp_f32 v111, -v79
    v_mfma_f32_16x16x32_bf16 v[56:59], v[28:31], a[232:235], v[56:59]
    buffer_load_dwordx4 v1, s[16:19], s43 offen offset:1024 lds
    v_mul_f32 v112, v76, v92
    v_mfma_f32_16x16x32_bf16 v[44:47], v[24:27], a[236:239], v[44:47]
    v_mul_f32 v113, v77, v93
    v_mfma_f32_16x16x32_bf16 v[60:63], v[28:31], a[236:239], v[60:63]
    s_waitcnt vmcnt(6) lgkmcnt(0)
    s_barrier
    v_mfma_f32_16x16x32_bf16 v[32:35], v[16:19], a[240:243], v[32:35]
    ds_read_b64_tr_b16 v[24:25], v2 offset:57344
    ds_read_b64_tr_b16 v[26:27], v2 offset:57856
    v_mfma_f32_16x16x32_bf16 v[48:51], v[20:23], a[240:243], v[48:51]
    ds_read_b64_tr_b16 v[28:29], v2 offset:58368
    ds_read_b64_tr_b16 v[30:31], v2 offset:58880
    v_mfma_f32_16x16x32_bf16 v[36:39], v[16:19], a[244:247], v[36:39]
    s_add_u32 m0, s36, 32768
    v_mul_f32 v114, v78, v94
    v_mfma_f32_16x16x32_bf16 v[52:55], v[20:23], a[244:247], v[52:55]
    buffer_load_dwordx4 v1, s[12:15], s44 offen lds
    v_mul_f32 v115, v79, v95
    v_mfma_f32_16x16x32_bf16 v[40:43], v[16:19], a[248:251], v[40:43]
    buffer_load_dwordx4 v1, s[16:19], s44 offen offset:1024 lds
    v_fma_f32 v108, v108, s39, s39
    v_mfma_f32_16x16x32_bf16 v[56:59], v[20:23], a[248:251], v[56:59]
    v_fma_f32 v109, v109, s39, s39
    v_fma_f32 v110, v110, s39, s39
    v_mfma_f32_16x16x32_bf16 v[44:47], v[16:19], a[252:255], v[44:47]
    v_fma_f32 v111, v111, s39, s39
    v_mfma_f32_16x16x32_bf16 v[60:63], v[20:23], a[252:255], v[60:63]
    v_rcp_f32 v108, v108
    s_waitcnt lgkmcnt(0)
    v_mfma_f32_16x16x32_bf16 v[32:35], v[24:27], v[224:227], v[32:35]
    ds_read_b64_tr_b16 v[16:17], v3 offset:0
    ds_read_b64_tr_b16 v[18:19], v3 offset:512
    v_mfma_f32_16x16x32_bf16 v[48:51], v[28:31], v[224:227], v[48:51]
    ds_read_b64_tr_b16 v[20:21], v3 offset:1024
    ds_read_b64_tr_b16 v[22:23], v3 offset:1536
    v_mfma_f32_16x16x32_bf16 v[36:39], v[24:27], v[228:231], v[36:39]
    s_add_u32 m0, s36, 40960
    v_mfma_f32_16x16x32_bf16 v[52:55], v[28:31], v[228:231], v[52:55]
    v_rcp_f32 v109, v109
    buffer_load_dwordx4 v1, s[12:15], s45 offen lds
    v_mfma_f32_16x16x32_bf16 v[40:43], v[24:27], v[232:235], v[40:43]
    v_rcp_f32 v110, v110
    v_mfma_f32_16x16x32_bf16 v[56:59], v[28:31], v[232:235], v[56:59]
    buffer_load_dwordx4 v1, s[16:19], s45 offen offset:1024 lds
    v_mfma_f32_16x16x32_bf16 v[44:47], v[24:27], v[236:239], v[44:47]
    v_rcp_f32 v111, v111
    v_mul_f32 v112, v112, v108
    v_mfma_f32_16x16x32_bf16 v[60:63], v[28:31], v[236:239], v[60:63]
    s_waitcnt lgkmcnt(0)
    v_mfma_f32_16x16x32_bf16 v[32:35], v[16:19], v[240:243], v[32:35]
    ds_read_b64_tr_b16 v[24:25], v2 offset:0
    ds_read_b64_tr_b16 v[26:27], v2 offset:512
    v_mfma_f32_16x16x32_bf16 v[48:51], v[20:23], v[240:243], v[48:51]
    ds_read_b64_tr_b16 v[28:29], v2 offset:1024
    ds_read_b64_tr_b16 v[30:31], v2 offset:1536
    v_mfma_f32_16x16x32_bf16 v[36:39], v[16:19], v[244:247], v[36:39]
    s_add_u32 m0, s36, 49152
    v_mul_f32 v113, v113, v109
    v_mfma_f32_16x16x32_bf16 v[52:55], v[20:23], v[244:247], v[52:55]
    buffer_load_dwordx4 v1, s[12:15], s46 offen lds
    v_mul_f32 v114, v114, v110
    v_mfma_f32_16x16x32_bf16 v[40:43], v[16:19], v[248:251], v[40:43]
    buffer_load_dwordx4 v1, s[16:19], s46 offen offset:1024 lds
    v_mul_f32 v115, v115, v111
    v_mfma_f32_16x16x32_bf16 v[56:59], v[20:23], v[248:251], v[56:59]
    v_cvt_pk_bf16_f32 v116, v112, v113
    v_cvt_pk_bf16_f32 v117, v114, v115
    v_mfma_f32_16x16x32_bf16 v[44:47], v[16:19], v[252:255], v[44:47]
    ds_write_b64 v6, v[116:117] offset:3072
    v_add_u32 v6, 8192, v6
    v_mfma_f32_16x16x32_bf16 v[60:63], v[20:23], v[252:255], v[60:63]
    s_sub_u32 s37, s37, 1
    s_cmp_lg_u32 s37, 0
    s_cbranch_scc1 L_recurrent_scan__spectral_fnet__swiglu_ffn__prompt_kernel_p1_7
    ds_read_b128 a[0:3], v7 offset:0
    ds_read_b128 a[4:7], v7 offset:1024
    ds_read_b128 a[8:11], v7 offset:2048
    ds_read_b128 a[12:15], v7 offset:3072
    ds_read_b128 a[16:19], v7 offset:4096
    ds_read_b128 a[20:23], v7 offset:5120
    ds_read_b128 a[24:27], v7 offset:6144
    ds_read_b128 a[28:31], v7 offset:7168
    s_waitcnt vmcnt(6) lgkmcnt(0)
    s_barrier
    v_mfma_f32_16x16x32_bf16 v[64:67], v[24:27], a[0:3], 0
    ds_read_b64_tr_b16 v[16:17], v2 offset:8192
    ds_read_b64_tr_b16 v[18:19], v2 offset:8704
    ds_read_b64_tr_b16 v[20:21], v2 offset:9216
    ds_read_b64_tr_b16 v[22:23], v2 offset:9728
    v_mfma_f32_16x16x32_bf16 v[68:71], v[24:27], a[4:7], 0
    s_add_u32 m0, s36, 57344
    ds_read_b128 a[32:35], v7 offset:8192
    buffer_load_dwordx4 v1, s[12:15], s47 offen lds
    ds_read_b128 a[36:39], v7 offset:9216
    buffer_load_dwordx4 v1, s[16:19], s47 offen offset:1024 lds
    v_mfma_f32_16x16x32_bf16 v[72:75], v[24:27], a[8:11], 0
    ds_read_b128 a[40:43], v7 offset:10240
    ds_read_b128 a[44:47], v7 offset:11264
    ds_read_b128 a[48:51], v7 offset:12288
    ds_read_b128 a[52:55], v7 offset:13312
    v_mfma_f32_16x16x32_bf16 v[76:79], v[24:27], a[12:15], 0
    ds_read_b128 a[56:59], v7 offset:14336
    ds_read_b128 a[60:63], v7 offset:15360
    v_exp_f32 v96, -v32
    v_mfma_f32_16x16x32_bf16 v[64:67], v[28:31], a[16:19], v[64:67]
    v_exp_f32 v97, -v33
    v_exp_f32 v98, -v34
    v_exp_f32 v99, -v35
    v_mfma_f32_16x16x32_bf16 v[68:71], v[28:31], a[20:23], v[68:71]
    v_mul_f32 v100, v32, v48
    v_mul_f32 v101, v33, v49
    v_mul_f32 v102, v34, v50
    v_mul_f32 v103, v35, v51
    v_mfma_f32_16x16x32_bf16 v[72:75], v[28:31], a[24:27], v[72:75]
    v_fma_f32 v96, v96, s39, s39
    v_fma_f32 v97, v97, s39, s39
    v_fma_f32 v98, v98, s39, s39
    v_fma_f32 v99, v99, s39, s39
    v_mfma_f32_16x16x32_bf16 v[76:79], v[28:31], a[28:31], v[76:79]
    v_rcp_f32 v96, v96
    v_rcp_f32 v97, v97
    v_rcp_f32 v98, v98
    s_waitcnt lgkmcnt(0)
    v_mfma_f32_16x16x32_bf16 v[64:67], v[16:19], a[32:35], v[64:67]
    ds_read_b64_tr_b16 v[24:25], v2 offset:16384
    ds_read_b64_tr_b16 v[26:27], v2 offset:16896
    ds_read_b64_tr_b16 v[28:29], v2 offset:17408
    ds_read_b64_tr_b16 v[30:31], v2 offset:17920
    v_mfma_f32_16x16x32_bf16 v[68:71], v[16:19], a[36:39], v[68:71]
    s_add_u32 m0, s36, 65536
    ds_read_b128 a[64:67], v7 offset:16384
    buffer_load_dwordx4 v1, s[12:15], s48 offen lds
    ds_read_b128 a[68:71], v7 offset:17408
    v_mfma_f32_16x16x32_bf16 v[72:75], v[16:19], a[40:43], v[72:75]
    buffer_load_dwordx4 v1, s[16:19], s48 offen offset:1024 lds
    ds_read_b128 a[72:75], v7 offset:18432
    ds_read_b128 a[76:79], v7 offset:19456
    ds_read_b128 a[80:83], v7 offset:20480
    ds_read_b128 a[84:87], v7 offset:21504
    v_mfma_f32_16x16x32_bf16 v[76:79], v[16:19], a[44:47], v[76:79]
    ds_read_b128 a[88:91], v7 offset:22528
    ds_read_b128 a[92:95], v7 offset:23552
    v_rcp_f32 v99, v99
    v_mfma_f32_16x16x32_bf16 v[64:67], v[20:23], a[48:51], v[64:67]
    v_mul_f32 v100, v100, v96
    v_mul_f32 v101, v101, v97
    v_mul_f32 v102, v102, v98
    v_mul_f32 v103, v103, v99
    v_mfma_f32_16x16x32_bf16 v[68:71], v[20:23], a[52:55], v[68:71]
    v_cvt_pk_bf16_f32 v104, v100, v101
    v_cvt_pk_bf16_f32 v105, v102, v103
    ds_write_b64 v6, v[104:105] offset:0
    v_exp_f32 v108, -v36
    v_mfma_f32_16x16x32_bf16 v[72:75], v[20:23], a[56:59], v[72:75]
    v_exp_f32 v109, -v37
    v_exp_f32 v110, -v38
    v_mfma_f32_16x16x32_bf16 v[76:79], v[20:23], a[60:63], v[76:79]
    v_exp_f32 v111, -v39
    v_mul_f32 v112, v36, v52
    v_mul_f32 v113, v37, v53
    v_mul_f32 v114, v38, v54
    v_add_u32 v1, 128, v1
    s_waitcnt lgkmcnt(1)
    v_mfma_f32_16x16x32_bf16 v[64:67], v[24:27], a[64:67], v[64:67]
    ds_read_b64_tr_b16 v[16:17], v2 offset:24576
    ds_read_b64_tr_b16 v[18:19], v2 offset:25088
    ds_read_b64_tr_b16 v[20:21], v2 offset:25600
    ds_read_b64_tr_b16 v[22:23], v2 offset:26112
    v_mfma_f32_16x16x32_bf16 v[68:71], v[24:27], a[68:71], v[68:71]
    s_add_u32 m0, s36, 0
    ds_read_b128 a[96:99], v7 offset:24576
    buffer_load_dwordx4 v1, s[12:15], s40 offen lds
    ds_read_b128 a[100:103], v7 offset:25600
    buffer_load_dwordx4 v1, s[16:19], s40 offen offset:1024 lds
    v_mfma_f32_16x16x32_bf16 v[72:75], v[24:27], a[72:75], v[72:75]
    ds_read_b128 a[104:107], v7 offset:26624
    ds_read_b128 a[108:111], v7 offset:27648
    ds_read_b128 a[112:115], v7 offset:28672
    ds_read_b128 a[116:119], v7 offset:29696
    v_mfma_f32_16x16x32_bf16 v[76:79], v[24:27], a[76:79], v[76:79]
    ds_read_b128 a[120:123], v7 offset:30720
    ds_read_b128 a[124:127], v7 offset:31744
    v_mul_f32 v115, v39, v55
    v_fma_f32 v108, v108, s39, s39
    v_fma_f32 v109, v109, s39, s39
    v_mfma_f32_16x16x32_bf16 v[64:67], v[28:31], a[80:83], v[64:67]
    v_fma_f32 v110, v110, s39, s39
    v_fma_f32 v111, v111, s39, s39
    v_rcp_f32 v108, v108
    v_mfma_f32_16x16x32_bf16 v[68:71], v[28:31], a[84:87], v[68:71]
    v_rcp_f32 v109, v109
    v_rcp_f32 v110, v110
    v_mfma_f32_16x16x32_bf16 v[72:75], v[28:31], a[88:91], v[72:75]
    v_rcp_f32 v111, v111
    v_mul_f32 v112, v112, v108
    v_mul_f32 v113, v113, v109
    v_mul_f32 v114, v114, v110
    v_mul_f32 v115, v115, v111
    v_mfma_f32_16x16x32_bf16 v[76:79], v[28:31], a[92:95], v[76:79]
    v_cvt_pk_bf16_f32 v116, v112, v113
    v_cvt_pk_bf16_f32 v117, v114, v115
    ds_write_b64 v6, v[116:117] offset:1024
    v_exp_f32 v96, -v40
    s_waitcnt vmcnt(6) lgkmcnt(0)
    s_barrier
    v_mfma_f32_16x16x32_bf16 v[64:67], v[16:19], a[96:99], v[64:67]
    ds_read_b64_tr_b16 v[24:25], v2 offset:32768
    ds_read_b64_tr_b16 v[26:27], v2 offset:33280
    ds_read_b64_tr_b16 v[28:29], v2 offset:33792
    ds_read_b64_tr_b16 v[30:31], v2 offset:34304
    v_mfma_f32_16x16x32_bf16 v[68:71], v[16:19], a[100:103], v[68:71]
    s_add_u32 m0, s36, 8192
    ds_read_b128 a[128:131], v7 offset:32768
    buffer_load_dwordx4 v1, s[12:15], s41 offen lds
    ds_read_b128 a[132:135], v7 offset:33792
    v_mfma_f32_16x16x32_bf16 v[72:75], v[16:19], a[104:107], v[72:75]
    buffer_load_dwordx4 v1, s[16:19], s41 offen offset:1024 lds
    ds_read_b128 a[136:139], v7 offset:34816
    ds_read_b128 a[140:143], v7 offset:35840
    ds_read_b128 a[144:147], v7 offset:36864
    ds_read_b128 a[148:151], v7 offset:37888
    v_mfma_f32_16x16x32_bf16 v[76:79], v[16:19], a[108:111], v[76:79]
    ds_read_b128 a[152:155], v7 offset:38912
    ds_read_b128 a[156:159], v7 offset:39936
    v_exp_f32 v97, -v41
    v_mfma_f32_16x16x32_bf16 v[64:67], v[20:23], a[112:115], v[64:67]
    v_exp_f32 v98, -v42
    v_exp_f32 v99, -v43
    v_mfma_f32_16x16x32_bf16 v[68:71], v[20:23], a[116:119], v[68:71]
    v_mul_f32 v100, v40, v56
    v_mul_f32 v101, v41, v57
    v_mul_f32 v102, v42, v58
    v_mul_f32 v103, v43, v59
    v_fma_f32 v96, v96, s39, s39
    v_mfma_f32_16x16x32_bf16 v[72:75], v[20:23], a[120:123], v[72:75]
    v_fma_f32 v97, v97, s39, s39
    v_fma_f32 v98, v98, s39, s39
    v_fma_f32 v99, v99, s39, s39
    v_mfma_f32_16x16x32_bf16 v[76:79], v[20:23], a[124:127], v[76:79]
    v_rcp_f32 v96, v96
    v_rcp_f32 v97, v97
    v_rcp_f32 v98, v98
    s_waitcnt lgkmcnt(0)
    v_mfma_f32_16x16x32_bf16 v[64:67], v[24:27], a[128:131], v[64:67]
    ds_read_b64_tr_b16 v[16:17], v2 offset:40960
    ds_read_b64_tr_b16 v[18:19], v2 offset:41472
    ds_read_b64_tr_b16 v[20:21], v2 offset:41984
    ds_read_b64_tr_b16 v[22:23], v2 offset:42496
    v_mfma_f32_16x16x32_bf16 v[68:71], v[24:27], a[132:135], v[68:71]
    s_add_u32 m0, s36, 16384
    ds_read_b128 a[160:163], v7 offset:40960
    buffer_load_dwordx4 v1, s[12:15], s42 offen lds
    ds_read_b128 a[164:167], v7 offset:41984
    buffer_load_dwordx4 v1, s[16:19], s42 offen offset:1024 lds
    v_mfma_f32_16x16x32_bf16 v[72:75], v[24:27], a[136:139], v[72:75]
    ds_read_b128 a[168:171], v7 offset:43008
    ds_read_b128 a[172:175], v7 offset:44032
    ds_read_b128 a[176:179], v7 offset:45056
    ds_read_b128 a[180:183], v7 offset:46080
    v_mfma_f32_16x16x32_bf16 v[76:79], v[24:27], a[140:143], v[76:79]
    ds_read_b128 a[184:187], v7 offset:47104
    ds_read_b128 a[188:191], v7 offset:48128
    v_rcp_f32 v99, v99
    v_mul_f32 v100, v100, v96
    v_mfma_f32_16x16x32_bf16 v[64:67], v[28:31], a[144:147], v[64:67]
    v_mul_f32 v101, v101, v97
    v_mul_f32 v102, v102, v98
    v_mul_f32 v103, v103, v99
    v_cvt_pk_bf16_f32 v104, v100, v101
    v_mfma_f32_16x16x32_bf16 v[68:71], v[28:31], a[148:151], v[68:71]
    v_cvt_pk_bf16_f32 v105, v102, v103
    ds_write_b64 v6, v[104:105] offset:2048
    v_exp_f32 v108, -v44
    v_mfma_f32_16x16x32_bf16 v[72:75], v[28:31], a[152:155], v[72:75]
    v_exp_f32 v109, -v45
    v_exp_f32 v110, -v46
    v_mfma_f32_16x16x32_bf16 v[76:79], v[28:31], a[156:159], v[76:79]
    v_exp_f32 v111, -v47
    v_mul_f32 v112, v44, v60
    v_mul_f32 v113, v45, v61
    v_mul_f32 v114, v46, v62
    v_mul_f32 v115, v47, v63
    s_waitcnt lgkmcnt(1)
    v_mfma_f32_16x16x32_bf16 v[64:67], v[16:19], a[160:163], v[64:67]
    ds_read_b64_tr_b16 v[24:25], v2 offset:49152
    ds_read_b64_tr_b16 v[26:27], v2 offset:49664
    ds_read_b64_tr_b16 v[28:29], v2 offset:50176
    ds_read_b64_tr_b16 v[30:31], v2 offset:50688
    v_mfma_f32_16x16x32_bf16 v[68:71], v[16:19], a[164:167], v[68:71]
    s_add_u32 m0, s36, 24576
    ds_read_b128 a[192:195], v7 offset:49152
    buffer_load_dwordx4 v1, s[12:15], s43 offen lds
    ds_read_b128 a[196:199], v7 offset:50176
    v_mfma_f32_16x16x32_bf16 v[72:75], v[16:19], a[168:171], v[72:75]
    buffer_load_dwordx4 v1, s[16:19], s43 offen offset:1024 lds
    ds_read_b128 a[200:203], v7 offset:51200
    ds_read_b128 a[204:207], v7 offset:52224
    ds_read_b128 a[208:211], v7 offset:53248
    ds_read_b128 a[212:215], v7 offset:54272
    v_mfma_f32_16x16x32_bf16 v[76:79], v[16:19], a[172:175], v[76:79]
    ds_read_b128 a[216:219], v7 offset:55296
    ds_read_b128 a[220:223], v7 offset:56320
    v_fma_f32 v108, v108, s39, s39
    v_fma_f32 v109, v109, s39, s39
    v_mfma_f32_16x16x32_bf16 v[64:67], v[20:23], a[176:179], v[64:67]
    v_fma_f32 v110, v110, s39, s39
    v_fma_f32 v111, v111, s39, s39
    v_rcp_f32 v108, v108
    v_mfma_f32_16x16x32_bf16 v[68:71], v[20:23], a[180:183], v[68:71]
    v_rcp_f32 v109, v109
    v_rcp_f32 v110, v110
    v_mfma_f32_16x16x32_bf16 v[72:75], v[20:23], a[184:187], v[72:75]
    v_rcp_f32 v111, v111
    v_mul_f32 v112, v112, v108
    v_mul_f32 v113, v113, v109
    v_mul_f32 v114, v114, v110
    v_mfma_f32_16x16x32_bf16 v[76:79], v[20:23], a[188:191], v[76:79]
    v_mul_f32 v115, v115, v111
    v_cvt_pk_bf16_f32 v116, v112, v113
    v_cvt_pk_bf16_f32 v117, v114, v115
    ds_write_b64 v6, v[116:117] offset:3072
    v_add_u32 v6, 8192, v6
    s_waitcnt vmcnt(6) lgkmcnt(0)
    s_barrier
    v_mfma_f32_16x16x32_bf16 v[64:67], v[24:27], a[192:195], v[64:67]
    ds_read_b64_tr_b16 v[16:17], v2 offset:57344
    ds_read_b64_tr_b16 v[18:19], v2 offset:57856
    v_mfma_f32_16x16x32_bf16 v[68:71], v[24:27], a[196:199], v[68:71]
    ds_read_b64_tr_b16 v[20:21], v2 offset:58368
    ds_read_b64_tr_b16 v[22:23], v2 offset:58880
    v_mfma_f32_16x16x32_bf16 v[72:75], v[24:27], a[200:203], v[72:75]
    s_add_u32 m0, s36, 32768
    ds_read_b128 a[224:227], v7 offset:57344
    v_mfma_f32_16x16x32_bf16 v[76:79], v[24:27], a[204:207], v[76:79]
    buffer_load_dwordx4 v1, s[12:15], s44 offen lds
    ds_read_b128 a[228:231], v7 offset:58368
    v_mfma_f32_16x16x32_bf16 v[64:67], v[28:31], a[208:211], v[64:67]
    buffer_load_dwordx4 v1, s[16:19], s44 offen offset:1024 lds
    ds_read_b128 a[232:235], v7 offset:59392
    v_mfma_f32_16x16x32_bf16 v[68:71], v[28:31], a[212:215], v[68:71]
    ds_read_b128 a[236:239], v7 offset:60416
    ds_read_b128 a[240:243], v7 offset:61440
    v_mfma_f32_16x16x32_bf16 v[72:75], v[28:31], a[216:219], v[72:75]
    ds_read_b128 a[244:247], v7 offset:62464
    ds_read_b128 a[248:251], v7 offset:63488
    v_mfma_f32_16x16x32_bf16 v[76:79], v[28:31], a[220:223], v[76:79]
    ds_read_b128 a[252:255], v7 offset:64512
    s_waitcnt lgkmcnt(0)
    v_mfma_f32_16x16x32_bf16 v[64:67], v[16:19], a[224:227], v[64:67]
    ds_read_b64_tr_b16 v[24:25], v3 offset:0
    ds_read_b64_tr_b16 v[26:27], v3 offset:512
    v_mfma_f32_16x16x32_bf16 v[68:71], v[16:19], a[228:231], v[68:71]
    ds_read_b64_tr_b16 v[28:29], v3 offset:1024
    ds_read_b64_tr_b16 v[30:31], v3 offset:1536
    v_mfma_f32_16x16x32_bf16 v[72:75], v[16:19], a[232:235], v[72:75]
    s_add_u32 m0, s36, 40960
    ds_read_b128 v[224:227], v8 offset:0
    v_mfma_f32_16x16x32_bf16 v[76:79], v[16:19], a[236:239], v[76:79]
    buffer_load_dwordx4 v1, s[12:15], s45 offen lds
    ds_read_b128 v[228:231], v8 offset:1024
    v_mfma_f32_16x16x32_bf16 v[64:67], v[20:23], a[240:243], v[64:67]
    buffer_load_dwordx4 v1, s[16:19], s45 offen offset:1024 lds
    ds_read_b128 v[232:235], v8 offset:2048
    v_mfma_f32_16x16x32_bf16 v[68:71], v[20:23], a[244:247], v[68:71]
    ds_read_b128 v[236:239], v8 offset:3072
    ds_read_b128 v[240:243], v8 offset:4096
    v_mfma_f32_16x16x32_bf16 v[72:75], v[20:23], a[248:251], v[72:75]
    ds_read_b128 v[244:247], v8 offset:5120
    ds_read_b128 v[248:251], v8 offset:6144
    v_mfma_f32_16x16x32_bf16 v[76:79], v[20:23], a[252:255], v[76:79]
    ds_read_b128 v[252:255], v8 offset:7168
    s_waitcnt lgkmcnt(0)
    v_mfma_f32_16x16x32_bf16 v[64:67], v[24:27], v[224:227], v[64:67]
    ds_read_b64_tr_b16 v[16:17], v2 offset:0
    ds_read_b64_tr_b16 v[18:19], v2 offset:512
    v_mfma_f32_16x16x32_bf16 v[68:71], v[24:27], v[228:231], v[68:71]
    ds_read_b64_tr_b16 v[20:21], v2 offset:1024
    ds_read_b64_tr_b16 v[22:23], v2 offset:1536
    v_mfma_f32_16x16x32_bf16 v[72:75], v[24:27], v[232:235], v[72:75]
    s_add_u32 m0, s36, 49152
    s_nop 0
    buffer_load_dwordx4 v1, s[12:15], s46 offen lds
    v_mfma_f32_16x16x32_bf16 v[76:79], v[24:27], v[236:239], v[76:79]
    buffer_load_dwordx4 v1, s[16:19], s46 offen offset:1024 lds
    v_mfma_f32_16x16x32_bf16 v[64:67], v[28:31], v[240:243], v[64:67]
    v_mfma_f32_16x16x32_bf16 v[68:71], v[28:31], v[244:247], v[68:71]
    v_mfma_f32_16x16x32_bf16 v[72:75], v[28:31], v[248:251], v[72:75]
    v_mfma_f32_16x16x32_bf16 v[76:79], v[28:31], v[252:255], v[76:79]
    s_mov_b32 s37, 4
L_recurrent_scan__spectral_fnet__swiglu_ffn__prompt_kernel_p2_8:
    s_waitcnt vmcnt(6) lgkmcnt(0)
    s_barrier
    v_mfma_f32_16x16x32_bf16 v[80:83], v[16:19], a[0:3], 0
    ds_read_b64_tr_b16 v[24:25], v2 offset:8192
    ds_read_b64_tr_b16 v[26:27], v2 offset:8704
    v_mfma_f32_16x16x32_bf16 v[84:87], v[16:19], a[4:7], 0
    ds_read_b64_tr_b16 v[28:29], v2 offset:9216
    ds_read_b64_tr_b16 v[30:31], v2 offset:9728
    v_mfma_f32_16x16x32_bf16 v[88:91], v[16:19], a[8:11], 0
    s_add_u32 m0, s36, 57344
    s_nop 0
    buffer_load_dwordx4 v1, s[12:15], s47 offen lds
    v_mfma_f32_16x16x32_bf16 v[92:95], v[16:19], a[12:15], 0
    buffer_load_dwordx4 v1, s[16:19], s47 offen offset:1024 lds
    v_mfma_f32_16x16x32_bf16 v[80:83], v[20:23], a[16:19], v[80:83]
    v_mfma_f32_16x16x32_bf16 v[84:87], v[20:23], a[20:23], v[84:87]
    v_mfma_f32_16x16x32_bf16 v[88:91], v[20:23], a[24:27], v[88:91]
    v_mfma_f32_16x16x32_bf16 v[92:95], v[20:23], a[28:31], v[92:95]
    s_waitcnt lgkmcnt(0)
    v_mfma_f32_16x16x32_bf16 v[80:83], v[24:27], a[32:35], v[80:83]
    ds_read_b64_tr_b16 v[16:17], v2 offset:16384
    ds_read_b64_tr_b16 v[18:19], v2 offset:16896
    v_mfma_f32_16x16x32_bf16 v[84:87], v[24:27], a[36:39], v[84:87]
    ds_read_b64_tr_b16 v[20:21], v2 offset:17408
    ds_read_b64_tr_b16 v[22:23], v2 offset:17920
    v_mfma_f32_16x16x32_bf16 v[88:91], v[24:27], a[40:43], v[88:91]
    s_add_u32 m0, s36, 65536
    v_cvt_pk_bf16_f32 v96, v64, v65
    v_mfma_f32_16x16x32_bf16 v[92:95], v[24:27], a[44:47], v[92:95]
    buffer_load_dwordx4 v1, s[12:15], s48 offen lds
    v_cvt_pk_bf16_f32 v97, v66, v67
    v_mfma_f32_16x16x32_bf16 v[80:83], v[28:31], a[48:51], v[80:83]
    buffer_load_dwordx4 v1, s[16:19], s48 offen offset:1024 lds
    v_cvt_pk_bf16_f32 v98, v68, v69
    v_mfma_f32_16x16x32_bf16 v[84:87], v[28:31], a[52:55], v[84:87]
    v_cvt_pk_bf16_f32 v99, v70, v71
    v_mfma_f32_16x16x32_bf16 v[88:91], v[28:31], a[56:59], v[88:91]
    v_mfma_f32_16x16x32_bf16 v[92:95], v[28:31], a[60:63], v[92:95]
    v_add_u32 v1, 128, v1
    s_waitcnt lgkmcnt(0)
    v_mfma_f32_16x16x32_bf16 v[80:83], v[16:19], a[64:67], v[80:83]
    ds_read_b64_tr_b16 v[24:25], v2 offset:24576
    ds_read_b64_tr_b16 v[26:27], v2 offset:25088
    v_mfma_f32_16x16x32_bf16 v[84:87], v[16:19], a[68:71], v[84:87]
    ds_read_b64_tr_b16 v[28:29], v2 offset:25600
    ds_read_b64_tr_b16 v[30:31], v2 offset:26112
    v_mfma_f32_16x16x32_bf16 v[88:91], v[16:19], a[72:75], v[88:91]
    s_add_u32 m0, s36, 0
    v_cvt_pk_bf16_f32 v100, v72, v73
    v_mfma_f32_16x16x32_bf16 v[92:95], v[16:19], a[76:79], v[92:95]
    buffer_load_dwordx4 v1, s[12:15], s40 offen lds
    v_cvt_pk_bf16_f32 v101, v74, v75
    v_mfma_f32_16x16x32_bf16 v[80:83], v[20:23], a[80:83], v[80:83]
    buffer_load_dwordx4 v1, s[16:19], s40 offen offset:1024 lds
    v_cvt_pk_bf16_f32 v102, v76, v77
    v_mfma_f32_16x16x32_bf16 v[84:87], v[20:23], a[84:87], v[84:87]
    v_cvt_pk_bf16_f32 v103, v78, v79
    v_mfma_f32_16x16x32_bf16 v[88:91], v[20:23], a[88:91], v[88:91]
    v_mfma_f32_16x16x32_bf16 v[92:95], v[20:23], a[92:95], v[92:95]
    s_waitcnt vmcnt(6) lgkmcnt(0)
    s_barrier
    v_mfma_f32_16x16x32_bf16 v[80:83], v[24:27], a[96:99], v[80:83]
    ds_read_b64_tr_b16 v[16:17], v2 offset:32768
    ds_read_b64_tr_b16 v[18:19], v2 offset:33280
    v_mfma_f32_16x16x32_bf16 v[84:87], v[24:27], a[100:103], v[84:87]
    ds_read_b64_tr_b16 v[20:21], v2 offset:33792
    ds_read_b64_tr_b16 v[22:23], v2 offset:34304
    v_mfma_f32_16x16x32_bf16 v[88:91], v[24:27], a[104:107], v[88:91]
    s_add_u32 m0, s36, 8192
    v_permlane16_swap_b32 v96, v98
    v_mfma_f32_16x16x32_bf16 v[92:95], v[24:27], a[108:111], v[92:95]
    buffer_load_dwordx4 v1, s[12:15], s41 offen lds
    v_permlane16_swap_b32 v97, v99
    v_mfma_f32_16x16x32_bf16 v[80:83], v[28:31], a[112:115], v[80:83]
    buffer_load_dwordx4 v1, s[16:19], s41 offen offset:1024 lds
    v_permlane16_swap_b32 v100, v102
    v_mfma_f32_16x16x32_bf16 v[84:87], v[28:31], a[116:119], v[84:87]
    v_permlane16_swap_b32 v101, v103
    v_mfma_f32_16x16x32_bf16 v[88:91], v[28:31], a[120:123], v[88:91]
    v_mfma_f32_16x16x32_bf16 v[92:95], v[28:31], a[124:127], v[92:95]
    s_waitcnt lgkmcnt(0)
    v_mfma_f32_16x16x32_bf16 v[80:83], v[16:19], a[128:131], v[80:83]
    ds_read_b64_tr_b16 v[24:25], v2 offset:40960
    ds_read_b64_tr_b16 v[26:27], v2 offset:41472
    v_mfma_f32_16x16x32_bf16 v[84:87], v[16:19], a[132:135], v[84:87]
    ds_read_b64_tr_b16 v[28:29], v2 offset:41984
    ds_read_b64_tr_b16 v[30:31], v2 offset:42496
    v_mfma_f32_16x16x32_bf16 v[88:91], v[16:19], a[136:139], v[88:91]
    s_add_u32 m0, s36, 16384
    buffer_store_dwordx4 v[96:99], v9, s[20:23], s58 offen offset:0 sc1
    v_mfma_f32_16x16x32_bf16 v[92:95], v[16:19], a[140:143], v[92:95]
    buffer_load_dwordx4 v1, s[12:15], s42 offen lds
    buffer_store_dwordx4 v[100:103], v9, s[20:23], s58 offen offset:1024 sc1
    v_mfma_f32_16x16x32_bf16 v[80:83], v[20:23], a[144:147], v[80:83]
    buffer_load_dwordx4 v1, s[16:19], s42 offen offset:1024 lds
    s_add_u32 s58, s58, 262144
    v_mfma_f32_16x16x32_bf16 v[84:87], v[20:23], a[148:151], v[84:87]
    v_mfma_f32_16x16x32_bf16 v[88:91], v[20:23], a[152:155], v[88:91]
    v_mfma_f32_16x16x32_bf16 v[92:95], v[20:23], a[156:159], v[92:95]
    s_waitcnt lgkmcnt(0)
    v_mfma_f32_16x16x32_bf16 v[80:83], v[24:27], a[160:163], v[80:83]
    ds_read_b64_tr_b16 v[16:17], v2 offset:49152
    ds_read_b64_tr_b16 v[18:19], v2 offset:49664
    v_mfma_f32_16x16x32_bf16 v[84:87], v[24:27], a[164:167], v[84:87]
    ds_read_b64_tr_b16 v[20:21], v2 offset:50176
    ds_read_b64_tr_b16 v[22:23], v2 offset:50688
    v_mfma_f32_16x16x32_bf16 v[88:91], v[24:27], a[168:171], v[88:91]
    s_add_u32 m0, s36, 24576
    s_nop 0
    buffer_load_dwordx4 v1, s[12:15], s43 offen lds
    v_mfma_f32_16x16x32_bf16 v[92:95], v[24:27], a[172:175], v[92:95]
    buffer_load_dwordx4 v1, s[16:19], s43 offen offset:1024 lds
    v_mfma_f32_16x16x32_bf16 v[80:83], v[28:31], a[176:179], v[80:83]
    v_mfma_f32_16x16x32_bf16 v[84:87], v[28:31], a[180:183], v[84:87]
    v_mfma_f32_16x16x32_bf16 v[88:91], v[28:31], a[184:187], v[88:91]
    v_mfma_f32_16x16x32_bf16 v[92:95], v[28:31], a[188:191], v[92:95]
    s_waitcnt vmcnt(8) lgkmcnt(0)
    s_barrier
    v_mfma_f32_16x16x32_bf16 v[80:83], v[16:19], a[192:195], v[80:83]
    ds_read_b64_tr_b16 v[24:25], v2 offset:57344
    ds_read_b64_tr_b16 v[26:27], v2 offset:57856
    v_mfma_f32_16x16x32_bf16 v[84:87], v[16:19], a[196:199], v[84:87]
    ds_read_b64_tr_b16 v[28:29], v2 offset:58368
    ds_read_b64_tr_b16 v[30:31], v2 offset:58880
    v_mfma_f32_16x16x32_bf16 v[88:91], v[16:19], a[200:203], v[88:91]
    s_add_u32 m0, s36, 32768
    buffer_load_dword v4, off, s[68:71], 0 sc1
    v_mfma_f32_16x16x32_bf16 v[92:95], v[16:19], a[204:207], v[92:95]
    buffer_load_dwordx4 v1, s[12:15], s44 offen lds
    buffer_load_dwordx4 v1, s[16:19], s44 offen offset:1024 lds
    v_mfma_f32_16x16x32_bf16 v[80:83], v[20:23], a[208:211], v[80:83]
    v_mfma_f32_16x16x32_bf16 v[84:87], v[20:23], a[212:215], v[84:87]
    v_mfma_f32_16x16x32_bf16 v[88:91], v[20:23], a[216:219], v[88:91]
    v_mfma_f32_16x16x32_bf16 v[92:95], v[20:23], a[220:223], v[92:95]
    s_waitcnt lgkmcnt(0)
    v_mfma_f32_16x16x32_bf16 v[80:83], v[24:27], a[224:227], v[80:83]
    ds_read_b64_tr_b16 v[16:17], v3 offset:0
    ds_read_b64_tr_b16 v[18:19], v3 offset:512
    v_mfma_f32_16x16x32_bf16 v[84:87], v[24:27], a[228:231], v[84:87]
    ds_read_b64_tr_b16 v[20:21], v3 offset:1024
    ds_read_b64_tr_b16 v[22:23], v3 offset:1536
    v_mfma_f32_16x16x32_bf16 v[88:91], v[24:27], a[232:235], v[88:91]
    s_add_u32 m0, s36, 40960
    s_nop 0
    buffer_load_dwordx4 v1, s[12:15], s45 offen lds
    v_mfma_f32_16x16x32_bf16 v[92:95], v[24:27], a[236:239], v[92:95]
    buffer_load_dwordx4 v1, s[16:19], s45 offen offset:1024 lds
    v_mfma_f32_16x16x32_bf16 v[80:83], v[28:31], a[240:243], v[80:83]
    v_mfma_f32_16x16x32_bf16 v[84:87], v[28:31], a[244:247], v[84:87]
    v_mfma_f32_16x16x32_bf16 v[88:91], v[28:31], a[248:251], v[88:91]
    v_mfma_f32_16x16x32_bf16 v[92:95], v[28:31], a[252:255], v[92:95]
    s_waitcnt lgkmcnt(0)
    v_mfma_f32_16x16x32_bf16 v[80:83], v[16:19], v[224:227], v[80:83]
    ds_read_b64_tr_b16 v[24:25], v2 offset:0
    ds_read_b64_tr_b16 v[26:27], v2 offset:512
    v_mfma_f32_16x16x32_bf16 v[84:87], v[16:19], v[228:231], v[84:87]
    ds_read_b64_tr_b16 v[28:29], v2 offset:1024
    ds_read_b64_tr_b16 v[30:31], v2 offset:1536
    v_mfma_f32_16x16x32_bf16 v[88:91], v[16:19], v[232:235], v[88:91]
    s_add_u32 m0, s36, 49152
    s_nop 0
    buffer_load_dwordx4 v1, s[12:15], s46 offen lds
    v_mfma_f32_16x16x32_bf16 v[92:95], v[16:19], v[236:239], v[92:95]
    buffer_load_dwordx4 v1, s[16:19], s46 offen offset:1024 lds
    v_mfma_f32_16x16x32_bf16 v[80:83], v[20:23], v[240:243], v[80:83]
    v_mfma_f32_16x16x32_bf16 v[84:87], v[20:23], v[244:247], v[84:87]
    v_mfma_f32_16x16x32_bf16 v[88:91], v[20:23], v[248:251], v[88:91]
    v_mfma_f32_16x16x32_bf16 v[92:95], v[20:23], v[252:255], v[92:95]
    s_waitcnt vmcnt(7) lgkmcnt(0)
    s_barrier
    v_mfma_f32_16x16x32_bf16 v[64:67], v[24:27], a[0:3], 0
    ds_read_b64_tr_b16 v[16:17], v2 offset:8192
    ds_read_b64_tr_b16 v[18:19], v2 offset:8704
    v_mfma_f32_16x16x32_bf16 v[68:71], v[24:27], a[4:7], 0
    ds_read_b64_tr_b16 v[20:21], v2 offset:9216
    ds_read_b64_tr_b16 v[22:23], v2 offset:9728
    v_mfma_f32_16x16x32_bf16 v[72:75], v[24:27], a[8:11], 0
    s_add_u32 m0, s36, 57344
    s_nop 0
    buffer_load_dwordx4 v1, s[12:15], s47 offen lds
    v_mfma_f32_16x16x32_bf16 v[76:79], v[24:27], a[12:15], 0
    buffer_load_dwordx4 v1, s[16:19], s47 offen offset:1024 lds
    v_mfma_f32_16x16x32_bf16 v[64:67], v[28:31], a[16:19], v[64:67]
    v_mfma_f32_16x16x32_bf16 v[68:71], v[28:31], a[20:23], v[68:71]
    v_mfma_f32_16x16x32_bf16 v[72:75], v[28:31], a[24:27], v[72:75]
    v_mfma_f32_16x16x32_bf16 v[76:79], v[28:31], a[28:31], v[76:79]
    s_waitcnt lgkmcnt(0)
    v_mfma_f32_16x16x32_bf16 v[64:67], v[16:19], a[32:35], v[64:67]
    ds_read_b64_tr_b16 v[24:25], v2 offset:16384
    ds_read_b64_tr_b16 v[26:27], v2 offset:16896
    v_mfma_f32_16x16x32_bf16 v[68:71], v[16:19], a[36:39], v[68:71]
    ds_read_b64_tr_b16 v[28:29], v2 offset:17408
    ds_read_b64_tr_b16 v[30:31], v2 offset:17920
    v_mfma_f32_16x16x32_bf16 v[72:75], v[16:19], a[40:43], v[72:75]
    s_add_u32 m0, s36, 65536
    v_cvt_pk_bf16_f32 v96, v80, v81
    v_mfma_f32_16x16x32_bf16 v[76:79], v[16:19], a[44:47], v[76:79]
    buffer_load_dwordx4 v1, s[12:15], s48 offen lds
    v_cvt_pk_bf16_f32 v97, v82, v83
    v_mfma_f32_16x16x32_bf16 v[64:67], v[20:23], a[48:51], v[64:67]
    buffer_load_dwordx4 v1, s[16:19], s48 offen offset:1024 lds
    v_cvt_pk_bf16_f32 v98, v84, v85
    v_mfma_f32_16x16x32_bf16 v[68:71], v[20:23], a[52:55], v[68:71]
    v_cvt_pk_bf16_f32 v99, v86, v87
    v_mfma_f32_16x16x32_bf16 v[72:75], v[20:23], a[56:59], v[72:75]
    v_mfma_f32_16x16x32_bf16 v[76:79], v[20:23], a[60:63], v[76:79]
    v_add_u32 v1, 128, v1
    s_cmp_eq_u32 s37, 1
    s_cselect_b32 s14, 0, s14
    s_cselect_b32 s18, 0, s18
    s_waitcnt lgkmcnt(0)
    v_mfma_f32_16x16x32_bf16 v[64:67], v[24:27], a[64:67], v[64:67]
    ds_read_b64_tr_b16 v[16:17], v2 offset:24576
    ds_read_b64_tr_b16 v[18:19], v2 offset:25088
    v_mfma_f32_16x16x32_bf16 v[68:71], v[24:27], a[68:71], v[68:71]
    ds_read_b64_tr_b16 v[20:21], v2 offset:25600
    ds_read_b64_tr_b16 v[22:23], v2 offset:26112
    v_mfma_f32_16x16x32_bf16 v[72:75], v[24:27], a[72:75], v[72:75]
    s_add_u32 m0, s36, 0
    v_cvt_pk_bf16_f32 v100, v88, v89
    v_mfma_f32_16x16x32_bf16 v[76:79], v[24:27], a[76:79], v[76:79]
    buffer_load_dwordx4 v1, s[12:15], s40 offen lds
    v_cvt_pk_bf16_f32 v101, v90, v91
    v_mfma_f32_16x16x32_bf16 v[64:67], v[28:31], a[80:83], v[64:67]
    buffer_load_dwordx4 v1, s[16:19], s40 offen offset:1024 lds
    v_cvt_pk_bf16_f32 v102, v92, v93
    v_mfma_f32_16x16x32_bf16 v[68:71], v[28:31], a[84:87], v[68:71]
    v_cvt_pk_bf16_f32 v103, v94, v95
    v_mfma_f32_16x16x32_bf16 v[72:75], v[28:31], a[88:91], v[72:75]
    v_mfma_f32_16x16x32_bf16 v[76:79], v[28:31], a[92:95], v[76:79]
    s_waitcnt vmcnt(6) lgkmcnt(0)
    s_barrier
    v_mfma_f32_16x16x32_bf16 v[64:67], v[16:19], a[96:99], v[64:67]
    ds_read_b64_tr_b16 v[24:25], v2 offset:32768
    ds_read_b64_tr_b16 v[26:27], v2 offset:33280
    v_mfma_f32_16x16x32_bf16 v[68:71], v[16:19], a[100:103], v[68:71]
    ds_read_b64_tr_b16 v[28:29], v2 offset:33792
    ds_read_b64_tr_b16 v[30:31], v2 offset:34304
    v_mfma_f32_16x16x32_bf16 v[72:75], v[16:19], a[104:107], v[72:75]
    s_add_u32 m0, s36, 8192
    v_permlane16_swap_b32 v96, v98
    v_mfma_f32_16x16x32_bf16 v[76:79], v[16:19], a[108:111], v[76:79]
    buffer_load_dwordx4 v1, s[12:15], s41 offen lds
    v_permlane16_swap_b32 v97, v99
    v_mfma_f32_16x16x32_bf16 v[64:67], v[20:23], a[112:115], v[64:67]
    buffer_load_dwordx4 v1, s[16:19], s41 offen offset:1024 lds
    v_permlane16_swap_b32 v100, v102
    v_mfma_f32_16x16x32_bf16 v[68:71], v[20:23], a[116:119], v[68:71]
    v_permlane16_swap_b32 v101, v103
    v_mfma_f32_16x16x32_bf16 v[72:75], v[20:23], a[120:123], v[72:75]
    v_mfma_f32_16x16x32_bf16 v[76:79], v[20:23], a[124:127], v[76:79]
    s_waitcnt lgkmcnt(0)
    v_mfma_f32_16x16x32_bf16 v[64:67], v[24:27], a[128:131], v[64:67]
    ds_read_b64_tr_b16 v[16:17], v2 offset:40960
    ds_read_b64_tr_b16 v[18:19], v2 offset:41472
    v_mfma_f32_16x16x32_bf16 v[68:71], v[24:27], a[132:135], v[68:71]
    ds_read_b64_tr_b16 v[20:21], v2 offset:41984
    ds_read_b64_tr_b16 v[22:23], v2 offset:42496
    v_mfma_f32_16x16x32_bf16 v[72:75], v[24:27], a[136:139], v[72:75]
    s_add_u32 m0, s36, 16384
    buffer_store_dwordx4 v[96:99], v9, s[20:23], s58 offen offset:0 sc1
    v_mfma_f32_16x16x32_bf16 v[76:79], v[24:27], a[140:143], v[76:79]
    buffer_load_dwordx4 v1, s[12:15], s42 offen lds
    buffer_store_dwordx4 v[100:103], v9, s[20:23], s58 offen offset:1024 sc1
    v_mfma_f32_16x16x32_bf16 v[64:67], v[28:31], a[144:147], v[64:67]
    buffer_load_dwordx4 v1, s[16:19], s42 offen offset:1024 lds
    s_add_u32 s58, s58, 262144
    v_mfma_f32_16x16x32_bf16 v[68:71], v[28:31], a[148:151], v[68:71]
    v_mfma_f32_16x16x32_bf16 v[72:75], v[28:31], a[152:155], v[72:75]
    v_mfma_f32_16x16x32_bf16 v[76:79], v[28:31], a[156:159], v[76:79]
    s_waitcnt lgkmcnt(0)
    v_mfma_f32_16x16x32_bf16 v[64:67], v[16:19], a[160:163], v[64:67]
    ds_read_b64_tr_b16 v[24:25], v2 offset:49152
    ds_read_b64_tr_b16 v[26:27], v2 offset:49664
    v_mfma_f32_16x16x32_bf16 v[68:71], v[16:19], a[164:167], v[68:71]
    ds_read_b64_tr_b16 v[28:29], v2 offset:50176
    ds_read_b64_tr_b16 v[30:31], v2 offset:50688
    v_mfma_f32_16x16x32_bf16 v[72:75], v[16:19], a[168:171], v[72:75]
    s_add_u32 m0, s36, 24576
    s_nop 0
    buffer_load_dwordx4 v1, s[12:15], s43 offen lds
    v_mfma_f32_16x16x32_bf16 v[76:79], v[16:19], a[172:175], v[76:79]
    buffer_load_dwordx4 v1, s[16:19], s43 offen offset:1024 lds
    v_mfma_f32_16x16x32_bf16 v[64:67], v[20:23], a[176:179], v[64:67]
    v_mfma_f32_16x16x32_bf16 v[68:71], v[20:23], a[180:183], v[68:71]
    v_mfma_f32_16x16x32_bf16 v[72:75], v[20:23], a[184:187], v[72:75]
    v_mfma_f32_16x16x32_bf16 v[76:79], v[20:23], a[188:191], v[76:79]
    s_waitcnt vmcnt(8) lgkmcnt(0)
    s_barrier
    v_mfma_f32_16x16x32_bf16 v[64:67], v[24:27], a[192:195], v[64:67]
    ds_read_b64_tr_b16 v[16:17], v2 offset:57344
    ds_read_b64_tr_b16 v[18:19], v2 offset:57856
    v_mfma_f32_16x16x32_bf16 v[68:71], v[24:27], a[196:199], v[68:71]
    ds_read_b64_tr_b16 v[20:21], v2 offset:58368
    ds_read_b64_tr_b16 v[22:23], v2 offset:58880
    v_mfma_f32_16x16x32_bf16 v[72:75], v[24:27], a[200:203], v[72:75]
    s_add_u32 m0, s36, 32768
    s_nop 0
    buffer_load_dwordx4 v1, s[12:15], s44 offen lds
    v_mfma_f32_16x16x32_bf16 v[76:79], v[24:27], a[204:207], v[76:79]
    buffer_load_dwordx4 v1, s[16:19], s44 offen offset:1024 lds
    v_mfma_f32_16x16x32_bf16 v[64:67], v[28:31], a[208:211], v[64:67]
    v_mfma_f32_16x16x32_bf16 v[68:71], v[28:31], a[212:215], v[68:71]
    v_mfma_f32_16x16x32_bf16 v[72:75], v[28:31], a[216:219], v[72:75]
    v_mfma_f32_16x16x32_bf16 v[76:79], v[28:31], a[220:223], v[76:79]
    s_waitcnt lgkmcnt(0)
    v_mfma_f32_16x16x32_bf16 v[64:67], v[16:19], a[224:227], v[64:67]
    ds_read_b64_tr_b16 v[24:25], v3 offset:0
    ds_read_b64_tr_b16 v[26:27], v3 offset:512
    v_mfma_f32_16x16x32_bf16 v[68:71], v[16:19], a[228:231], v[68:71]
    ds_read_b64_tr_b16 v[28:29], v3 offset:1024
    ds_read_b64_tr_b16 v[30:31], v3 offset:1536
    v_mfma_f32_16x16x32_bf16 v[72:75], v[16:19], a[232:235], v[72:75]
    s_add_u32 m0, s36, 40960
    s_nop 0
    buffer_load_dwordx4 v1, s[12:15], s45 offen lds
    v_mfma_f32_16x16x32_bf16 v[76:79], v[16:19], a[236:239], v[76:79]
    buffer_load_dwordx4 v1, s[16:19], s45 offen offset:1024 lds
    v_mfma_f32_16x16x32_bf16 v[64:67], v[20:23], a[240:243], v[64:67]
    v_mfma_f32_16x16x32_bf16 v[68:71], v[20:23], a[244:247], v[68:71]
    v_mfma_f32_16x16x32_bf16 v[72:75], v[20:23], a[248:251], v[72:75]
    v_mfma_f32_16x16x32_bf16 v[76:79], v[20:23], a[252:255], v[76:79]
    s_waitcnt lgkmcnt(0)
    v_mfma_f32_16x16x32_bf16 v[64:67], v[24:27], v[224:227], v[64:67]
    ds_read_b64_tr_b16 v[16:17], v2 offset:0
    ds_read_b64_tr_b16 v[18:19], v2 offset:512
    v_mfma_f32_16x16x32_bf16 v[68:71], v[24:27], v[228:231], v[68:71]
    ds_read_b64_tr_b16 v[20:21], v2 offset:1024
    ds_read_b64_tr_b16 v[22:23], v2 offset:1536
    v_mfma_f32_16x16x32_bf16 v[72:75], v[24:27], v[232:235], v[72:75]
    s_add_u32 m0, s36, 49152
    s_nop 0
    buffer_load_dwordx4 v1, s[12:15], s46 offen lds
    v_mfma_f32_16x16x32_bf16 v[76:79], v[24:27], v[236:239], v[76:79]
    buffer_load_dwordx4 v1, s[16:19], s46 offen offset:1024 lds
    v_mfma_f32_16x16x32_bf16 v[64:67], v[28:31], v[240:243], v[64:67]
    v_mfma_f32_16x16x32_bf16 v[68:71], v[28:31], v[244:247], v[68:71]
    v_mfma_f32_16x16x32_bf16 v[72:75], v[28:31], v[248:251], v[72:75]
    v_mfma_f32_16x16x32_bf16 v[76:79], v[28:31], v[252:255], v[76:79]
    s_sub_u32 s37, s37, 1
    s_cmp_lg_u32 s37, 0
    s_cbranch_scc1 L_recurrent_scan__spectral_fnet__swiglu_ffn__prompt_kernel_p2_8
    s_load_dwordx2 s[40:41], s[0:1], 0
    s_load_dwordx4 s[44:47], s[0:1], 8
    s_load_dwordx2 s[42:43], s[0:1], 72
    s_nop 7
    v_cvt_pk_bf16_f32 v96, v64, v65
    s_nop 1
    v_cvt_pk_bf16_f32 v97, v66, v67
    s_nop 1
    v_cvt_pk_bf16_f32 v98, v68, v69
    s_nop 1
    v_cvt_pk_bf16_f32 v99, v70, v71
    s_nop 1
    v_cvt_pk_bf16_f32 v100, v72, v73
    s_nop 1
    v_cvt_pk_bf16_f32 v101, v74, v75
    s_nop 1
    v_cvt_pk_bf16_f32 v102, v76, v77
    s_nop 1
    v_cvt_pk_bf16_f32 v103, v78, v79
    s_nop 1
    v_permlane16_swap_b32 v96, v98
    s_nop 1
    v_permlane16_swap_b32 v97, v99
    s_nop 1
    v_permlane16_swap_b32 v100, v102
    s_nop 1
    v_permlane16_swap_b32 v101, v103
    s_nop 1
    buffer_store_dwordx4 v[96:99], v9, s[20:23], s58 offen offset:0 sc1
    s_nop 1
    buffer_store_dwordx4 v[100:103], v9, s[20:23], s58 offen offset:1024 sc1
    s_nop 1
    s_add_u32 s58, s58, 262144
    s_nop 1
    v_mov_b32 v158, 1
    s_cmp_lt_u32 s2, 198
    s_cbranch_scc1 L_recurrent_scan__spectral_fnet__swiglu_ffn__prompt_kernel_role_9
    s_waitcnt vmcnt(0)
    s_barrier
    s_lshr_b32 s65, s2, 3
    s_lshl_b32 s65, s65, 2
    s_cmp_eq_u32 s5, 0
    s_cselect_b32 exec_lo, 1, 0
    s_mov_b32 exec_hi, 0
    buffer_atomic_add v158, off, s[68:71], s65 offset:128 sc1
    s_mov_b64 exec, -1
    s_branch L_recurrent_scan__spectral_fnet__swiglu_ffn__prompt_kernel_fin_10
L_recurrent_scan__spectral_fnet__swiglu_ffn__prompt_kernel_role_9:
    s_movk_i32 s61, 4096
    s_waitcnt vmcnt(28)
L_recurrent_scan__spectral_fnet__swiglu_ffn__prompt_kernel_eospin_11:
    v_readfirstlane_b32 s62, v4
    s_nop 0
    s_cmp_ge_u32 s62, 256
    s_cbranch_scc1 L_recurrent_scan__spectral_fnet__swiglu_ffn__prompt_kernel_eordy_12
    buffer_load_dword v4, off, s[68:71], 0 sc1
    s_sub_u32 s61, s61, 1
    s_cmp_lg_u32 s61, 0
    s_waitcnt vmcnt(0)
    s_cbranch_scc1 L_recurrent_scan__spectral_fnet__swiglu_ffn__prompt_kernel_eospin_11
L_recurrent_scan__spectral_fnet__swiglu_ffn__prompt_kernel_eordy_12:
    s_and_b32 s50, s2, 7
    s_lshr_b32 s51, s2, 3
    s_mul_i32 s52, s51, 43
    s_lshr_b32 s52, s52, 8
    s_mul_i32 s53, s52, 6
    s_sub_u32 s5, s51, s53
    s_lshr_b32 s3, s50, 2
    s_and_b32 s50, s50, 3
    s_lshl_b32 s50, s50, 2
    s_add_u32 s4, s50, s52
    s_sub_u32 s50, s2, 192
    s_cmp_ge_u32 s2, 192
    s_cselect_b32 s5, s50, s5
    s_cselect_b32 s3, 0, s3
    s_cselect_b32 s4, 16, s4
    v_and_b32 v1, 63, v0
    v_lshrrev_b32 v15, 6, v0
    v_and_b32 v2, 15, v1
    v_readfirstlane_b32 s6, v15
    v_lshrrev_b32 v3, 4, v1
    s_nop 1
    s_and_b32 s54, s6, 1
    s_lshr_b32 s55, s6, 1
    s_lshl_b32 s56, s4, 6
    s_add_u32 s56, s56, s3
    v_lshlrev_b32 v15, 1, v2
    v_add_u32 v15, s56, v15
    v_lshlrev_b32 v15, 12, v15
    v_lshlrev_b32 v4, 4, v3
    v_add_u32 v4, v4, v15
    s_lshl_b32 s57, s55, 9
    v_add_u32 v4, s57, v4
    v_add_u32 v5, 131072, v4
    v_lshlrev_b32 v15, 4, v1
    v_add_u32 v7, 16384, v15
    v_add_u32 v8, 32768, v15
    s_mov_b32 s58, 0x7ffffff0
    v_mov_b32 v251, s58
    v_cmp_eq_u32 vcc, 0, v2
    v_add_u32 v9, 49152, v15
    s_nop 0
    v_cndmask_b32 v9, v251, v9, vcc
    s_cmp_eq_u32 s5, 0
    s_cselect_b32 s59, s54, 0
    s_cmp_eq_u32 s5, 5
    s_cselect_b32 s60, s54, 0
    s_cmp_eq_u32 s59, 1
    s_cselect_b32 s59, 0x7ffffff0, 0
    s_cmp_eq_u32 s60, 1
    s_cselect_b32 s60, 0x7ffffff0, 0
    v_mov_b32 v252, s59
    v_cndmask_b32 v252, 0, v252, vcc
    v_or_b32 v6, v252, v15
    v_or_b32 v9, s60, v9
    s_mul_i32 s61, s3, 589824
    s_mul_i32 s62, s5, 49152
    s_add_u32 s61, s61, s62
    s_mul_i32 s62, s54, 294912
    s_add_u32 s61, s61, s62
    s_lshl_b32 s62, s55, 13
    s_add_u32 s24, s61, s62
    s_add_u32 s25, s24, 4096
    s_xor_b32 s61, s54, s3
    s_or_b32 s61, s61, s55
    s_cmp_eq_u32 s61, 0
    s_cselect_b32 s61, 0, 0x7ffffff0
    s_mul_i32 s62, s54, 1152
    s_mul_i32 s63, s5, 192
    s_add_u32 s62, s62, s63
    s_add_u32 s32, s62, 1179648
    v_lshlrev_b32 v10, 4, v3
    v_or_b32 v10, s61, v10
    v_or_b32 v11, s60, v10
    v_and_b32 v15, 1, v2
    v_xor_b32 v15, s3, v15
    v_lshlrev_b32 v15, 31, v15
    v_or_b32 v250, 0x3f800000, v15
    s_waitcnt lgkmcnt(0)
    s_cmp_eq_u32 s54, 0
    s_cselect_b32 s8, s44, s46
    s_cselect_b32 s9, s45, s47
    s_mov_b32 s10, 8388608
    s_mov_b32 s11, 0x00020000
    s_mov_b32 s16, s40
    s_mov_b32 s17, s41
    s_mov_b32 s18, 2359296
    s_mov_b32 s19, 0x00020000
    s_mov_b32 s12, s42
    s_mov_b32 s13, s43
    s_mov_b32 s14, 2359296
    s_mov_b32 s15, 0x00020000
    buffer_load_dwordx4 v[48:51], v10, s[20:23], s32 offen offset:0 sc1
    buffer_load_dwordx4 v[52:55], v10, s[20:23], s32 offen offset:64 sc1
    buffer_load_dwordx4 v[56:59], v10, s[20:23], s32 offen offset:128 sc1
    buffer_load_dwordx4 v[60:63], v11, s[20:23], s32 offen offset:192 sc1
    v_and_b32 v12, 31, v1
    v_lshlrev_b32 v12, 2, v12
    s_waitcnt vmcnt(4)
    s_barrier
    s_lshr_b32 s65, s2, 3
    s_lshl_b32 s65, s65, 2
    s_cmp_eq_u32 s6, 0
    s_cselect_b32 exec_lo, 1, 0
    s_mov_b32 exec_hi, 0
    buffer_atomic_add v158, off, s[68:71], s65 offset:128 sc1
    s_mov_b64 exec, -1
    v_and_b32 v15, 0xfe, v1
    v_add_u32 v15, s56, v15
    v_and_b32 v251, 1, v1
    s_movk_i32 s61, 512
    v_sub_u32 v252, 1024, v15
    v_cmp_gt_u32 vcc, s61, v15
    s_nop 1
    v_cndmask_b32 v252, v252, v15, vcc
    s_cmp_eq_u32 s55, 0
    s_cselect_b32 s62, 0, 3
    s_cselect_b32 s63, 1, 2
    s_cselect_b32 s64, 2, 3
    v_mov_b32 v253, s63
    v_mov_b32 v254, s62
    v_cndmask_b32 v253, v253, v254, vcc
    v_cmp_eq_u32 vcc, s61, v15
    v_mov_b32 v254, s64
    s_nop 0
    v_cndmask_b32 v253, v253, v254, vcc
    v_mov_b32 v254, 0
    v_cndmask_b32 v252, v252, v254, vcc
    v_lshrrev_b32 v254, 4, v252
    v_lshlrev_b32 v254, 11, v254
    v_lshlrev_b32 v253, 9, v253
    v_add_u32 v254, v254, v253
    v_and_b32 v253, 1, v252
    v_lshlrev_b32 v253, 8, v253
    v_add_u32 v254, v254, v253
    v_bfe_u32 v253, v252, 1, 3
    v_lshlrev_b32 v253, 5, v253
    v_add_u32 v254, v254, v253
    v_lshlrev_b32 v251, 4, v251
    v_add_u32 v254, v254, v251
    v_sub_u32 v253, 0x800, v15
    s_cmp_eq_u32 s55, 0
    s_cselect_b64 vcc, -1, 0
    s_cselect_b32 s62, 0, 1
    s_movk_i32 s64, 1023
    s_cselect_b32 s63, 1025, s64
    v_cndmask_b32 v253, v253, v15, vcc
    v_subrev_u32 v15, s62, v15
    v_cmp_gt_u32 vcc, s63, v15
    v_mul_u32_u24 v253, 0x480, v253
    v_add_u32 v253, v253, v251
    s_mul_i32 s62, s5, 3
    s_sub_u32 s63, 33, s62
    s_cmp_eq_u32 s54, 0
    s_cselect_b32 s62, s62, s63
    s_lshl_b32 s63, s62, 5
    v_add_u32 v253, s63, v253
    v_mov_b32 v252, s58
    v_cndmask_b32 v247, v252, v253, vcc
    s_lshl_b32 s63, s62, 16
    v_add_u32 v254, s63, v254
    v_cndmask_b32 v244, v252, v254, vcc
    v_add_u32 v245, 0x10000, v244
    v_add_u32 v246, 0x20000, v244
    s_mov_b32 s72, 2097152
    s_mov_b32 s73, 4456448
    s_mov_b32 s74, 6815744
    s_mov_b32 s75, 9175040
    s_mov_b32 s76, 11534336
    s_mov_b32 s77, 13893632
    s_mov_b32 s78, 16252928
    s_mov_b32 s79, 18612224
    buffer_load_dwordx4 a[128:131], v4, s[8:11], 0 offen offset:0
    buffer_load_dwordx4 a[132:135], v5, s[8:11], 0 offen offset:0
    buffer_load_dwordx4 a[0:3], v6, s[20:23], s24 offen offset:0 sc1
    buffer_load_dwordx4 a[4:7], v7, s[20:23], s24 offen offset:0 sc1
    buffer_load_dwordx4 a[8:11], v8, s[20:23], s24 offen offset:0 sc1
    buffer_load_dwordx4 a[12:15], v9, s[20:23], s24 offen offset:0 sc1
    buffer_load_dwordx4 a[136:139], v4, s[8:11], 0 offen offset:64
    buffer_load_dwordx4 a[140:143], v5, s[8:11], 0 offen offset:64
    buffer_load_dwordx4 a[16:19], v6, s[20:23], s24 offen offset:1024 sc1
    buffer_load_dwordx4 a[20:23], v7, s[20:23], s24 offen offset:1024 sc1
    buffer_load_dwordx4 a[24:27], v8, s[20:23], s24 offen offset:1024 sc1
    buffer_load_dwordx4 a[28:31], v9, s[20:23], s24 offen offset:1024 sc1
    buffer_load_dwordx4 a[144:147], v4, s[8:11], 0 offen offset:128
    buffer_load_dwordx4 a[148:151], v5, s[8:11], 0 offen offset:128
    buffer_load_dwordx4 a[32:35], v6, s[20:23], s24 offen offset:2048 sc1
    buffer_load_dwordx4 a[36:39], v7, s[20:23], s24 offen offset:2048 sc1
    buffer_load_dwordx4 a[40:43], v8, s[20:23], s24 offen offset:2048 sc1
    buffer_load_dwordx4 a[44:47], v9, s[20:23], s24 offen offset:2048 sc1
    buffer_load_dwordx4 a[152:155], v4, s[8:11], 0 offen offset:192
    buffer_load_dwordx4 a[156:159], v5, s[8:11], 0 offen offset:192
    buffer_load_dwordx4 a[48:51], v6, s[20:23], s24 offen offset:3072 sc1
    buffer_load_dwordx4 a[52:55], v7, s[20:23], s24 offen offset:3072 sc1
    buffer_load_dwordx4 a[56:59], v8, s[20:23], s24 offen offset:3072 sc1
    buffer_load_dwordx4 a[60:63], v9, s[20:23], s24 offen offset:3072 sc1
    buffer_load_dwordx4 a[160:163], v4, s[8:11], 0 offen offset:256
    buffer_load_dwordx4 a[164:167], v5, s[8:11], 0 offen offset:256
    buffer_load_dwordx4 a[64:67], v6, s[20:23], s25 offen offset:0 sc1
    buffer_load_dwordx4 a[68:71], v7, s[20:23], s25 offen offset:0 sc1
    buffer_load_dwordx4 a[72:75], v8, s[20:23], s25 offen offset:0 sc1
    buffer_load_dwordx4 a[76:79], v9, s[20:23], s25 offen offset:0 sc1
    buffer_load_dwordx4 a[168:171], v4, s[8:11], 0 offen offset:320
    buffer_load_dwordx4 a[172:175], v5, s[8:11], 0 offen offset:320
    buffer_load_dwordx4 a[80:83], v6, s[20:23], s25 offen offset:1024 sc1
    buffer_load_dwordx4 a[84:87], v7, s[20:23], s25 offen offset:1024 sc1
    buffer_load_dwordx4 a[88:91], v8, s[20:23], s25 offen offset:1024 sc1
    buffer_load_dwordx4 a[92:95], v9, s[20:23], s25 offen offset:1024 sc1
    buffer_load_dwordx4 a[176:179], v4, s[8:11], 0 offen offset:384
    buffer_load_dwordx4 a[180:183], v5, s[8:11], 0 offen offset:384
    buffer_load_dwordx4 a[96:99], v6, s[20:23], s25 offen offset:2048 sc1
    buffer_load_dwordx4 a[100:103], v7, s[20:23], s25 offen offset:2048 sc1
    buffer_load_dwordx4 a[104:107], v8, s[20:23], s25 offen offset:2048 sc1
    buffer_load_dwordx4 a[108:111], v9, s[20:23], s25 offen offset:2048 sc1
    buffer_load_dwordx4 a[184:187], v4, s[8:11], 0 offen offset:448
    buffer_load_dwordx4 a[188:191], v5, s[8:11], 0 offen offset:448
    buffer_load_dwordx4 a[112:115], v6, s[20:23], s25 offen offset:3072 sc1
    buffer_load_dwordx4 a[116:119], v7, s[20:23], s25 offen offset:3072 sc1
    buffer_load_dwordx4 a[120:123], v8, s[20:23], s25 offen offset:3072 sc1
    buffer_load_dwordx4 a[124:127], v9, s[20:23], s25 offen offset:3072 sc1
    buffer_load_dwordx4 v[160:163], v247, s[16:19], 0 offen offset:0
    buffer_load_dwordx4 v[164:167], v247, s[16:19], 0 offen offset:32
    buffer_load_dwordx4 v[168:171], v247, s[16:19], 0 offen offset:64
    v_mul_u32_u24 v248, 272, v2
    v_lshlrev_b32 v15, 4, v3
    v_add_u32 v248, v248, v15
    s_mul_i32 s63, s6, 8704
    s_add_u32 s63, s63, 73728
    v_add_u32 v248, s63, v248
    v_lshrrev_b32 v15, 1, v1
    v_mul_u32_u24 v249, 272, v15
    v_lshlrev_b32 v15, 1, v251
    v_sub_u32 v253, 32, v15
    s_cmp_eq_u32 s54, 0
    s_cselect_b64 vcc, -1, 0
    v_cndmask_b32 v15, v253, v15, vcc
    v_add_u32 v249, v249, v15
    v_add_u32 v249, 73728, v249
    s_xor_b32 s62, s54, s55
    s_cmp_eq_u32 s62, 0
    s_cselect_b32 s33, -1.0, 1.0
    s_mov_b32 s36, 0x00003f80
    s_mov_b32 s37, 0x3f800000
    s_mov_b32 s38, 0x40053526
    s_waitcnt vmcnt(52)
    v_cmp_gt_u32 vcc, 16, v1
    v_mov_b32 v252, s59
    s_nop 0
    v_cndmask_b32 v252, 0, v252, vcc
    v_cmp_eq_u32 vcc, 0, v252
    s_nop 1
    v_cndmask_b32 v48, 0, v48, vcc
    v_mul_f32 v16, v250, v48
    v_mul_f32 v17, v250, v49
    v_mul_f32 v18, v250, v50
    v_mul_f32 v19, v250, v51
    v_mul_f32 v20, v250, v52
    v_mul_f32 v21, v250, v53
    v_mul_f32 v22, v250, v54
    v_mul_f32 v23, v250, v55
    v_mul_f32 v24, v250, v56
    v_mul_f32 v25, v250, v57
    v_mul_f32 v26, v250, v58
    v_mul_f32 v27, v250, v59
    v_mul_f32 v28, v250, v60
    v_mul_f32 v29, v250, v61
    v_mul_f32 v30, v250, v62
    v_mul_f32 v31, v250, v63
    v_mul_f32 v32, v250, v48
    v_mul_f32 v33, v250, v49
    v_mul_f32 v34, v250, v50
    v_mul_f32 v35, v250, v51
    v_mul_f32 v36, v250, v52
    v_mul_f32 v37, v250, v53
    v_mul_f32 v38, v250, v54
    v_mul_f32 v39, v250, v55
    v_mul_f32 v40, v250, v56
    v_mul_f32 v41, v250, v57
    v_mul_f32 v42, v250, v58
    v_mul_f32 v43, v250, v59
    v_mul_f32 v44, v250, v60
    v_mul_f32 v45, v250, v61
    v_mul_f32 v46, v250, v62
    v_mul_f32 v47, v250, v63
    s_waitcnt vmcnt(45)
    v_mfma_f32_16x16x32_bf16 v[16:19], a[0:3], a[128:131], v[16:19]
    v_mfma_f32_16x16x32_bf16 v[32:35], a[0:3], a[132:135], v[32:35]
    v_mfma_f32_16x16x32_bf16 v[20:23], a[4:7], a[128:131], v[20:23]
    v_mfma_f32_16x16x32_bf16 v[36:39], a[4:7], a[132:135], v[36:39]
    v_mfma_f32_16x16x32_bf16 v[24:27], a[8:11], a[128:131], v[24:27]
    v_mfma_f32_16x16x32_bf16 v[40:43], a[8:11], a[132:135], v[40:43]
    v_mfma_f32_16x16x32_bf16 v[28:31], a[12:15], a[128:131], v[28:31]
    v_mfma_f32_16x16x32_bf16 v[44:47], a[12:15], a[132:135], v[44:47]
    s_waitcnt vmcnt(39)
    v_mfma_f32_16x16x32_bf16 v[16:19], a[16:19], a[136:139], v[16:19]
    v_mfma_f32_16x16x32_bf16 v[32:35], a[16:19], a[140:143], v[32:35]
    v_mfma_f32_16x16x32_bf16 v[20:23], a[20:23], a[136:139], v[20:23]
    v_mfma_f32_16x16x32_bf16 v[36:39], a[20:23], a[140:143], v[36:39]
    v_mfma_f32_16x16x32_bf16 v[24:27], a[24:27], a[136:139], v[24:27]
    v_mfma_f32_16x16x32_bf16 v[40:43], a[24:27], a[140:143], v[40:43]
    v_mfma_f32_16x16x32_bf16 v[28:31], a[28:31], a[136:139], v[28:31]
    v_mfma_f32_16x16x32_bf16 v[44:47], a[28:31], a[140:143], v[44:47]
    s_waitcnt vmcnt(33)
    v_mfma_f32_16x16x32_bf16 v[16:19], a[32:35], a[144:147], v[16:19]
    v_mfma_f32_16x16x32_bf16 v[32:35], a[32:35], a[148:151], v[32:35]
    v_mfma_f32_16x16x32_bf16 v[20:23], a[36:39], a[144:147], v[20:23]
    v_mfma_f32_16x16x32_bf16 v[36:39], a[36:39], a[148:151], v[36:39]
    v_mfma_f32_16x16x32_bf16 v[24:27], a[40:43], a[144:147], v[24:27]
    v_mfma_f32_16x16x32_bf16 v[40:43], a[40:43], a[148:151], v[40:43]
    v_mfma_f32_16x16x32_bf16 v[28:31], a[44:47], a[144:147], v[28:31]
    v_mfma_f32_16x16x32_bf16 v[44:47], a[44:47], a[148:151], v[44:47]
    s_waitcnt vmcnt(27)
    v_mfma_f32_16x16x32_bf16 v[16:19], a[48:51], a[152:155], v[16:19]
    v_mfma_f32_16x16x32_bf16 v[32:35], a[48:51], a[156:159], v[32:35]
    v_mfma_f32_16x16x32_bf16 v[20:23], a[52:55], a[152:155], v[20:23]
    v_mfma_f32_16x16x32_bf16 v[36:39], a[52:55], a[156:159], v[36:39]
    v_mfma_f32_16x16x32_bf16 v[24:27], a[56:59], a[152:155], v[24:27]
    v_mfma_f32_16x16x32_bf16 v[40:43], a[56:59], a[156:159], v[40:43]
    v_mfma_f32_16x16x32_bf16 v[28:31], a[60:63], a[152:155], v[28:31]
    v_mfma_f32_16x16x32_bf16 v[44:47], a[60:63], a[156:159], v[44:47]
    s_waitcnt vmcnt(21)
    v_mfma_f32_16x16x32_bf16 v[16:19], a[64:67], a[160:163], v[16:19]
    v_mfma_f32_16x16x32_bf16 v[32:35], a[64:67], a[164:167], v[32:35]
    v_mfma_f32_16x16x32_bf16 v[20:23], a[68:71], a[160:163], v[20:23]
    v_mfma_f32_16x16x32_bf16 v[36:39], a[68:71], a[164:167], v[36:39]
    v_mfma_f32_16x16x32_bf16 v[24:27], a[72:75], a[160:163], v[24:27]
    v_mfma_f32_16x16x32_bf16 v[40:43], a[72:75], a[164:167], v[40:43]
    v_mfma_f32_16x16x32_bf16 v[28:31], a[76:79], a[160:163], v[28:31]
    v_mfma_f32_16x16x32_bf16 v[44:47], a[76:79], a[164:167], v[44:47]
    s_waitcnt vmcnt(15)
    v_mfma_f32_16x16x32_bf16 v[16:19], a[80:83], a[168:171], v[16:19]
    v_mfma_f32_16x16x32_bf16 v[32:35], a[80:83], a[172:175], v[32:35]
    v_mfma_f32_16x16x32_bf16 v[20:23], a[84:87], a[168:171], v[20:23]
    v_mfma_f32_16x16x32_bf16 v[36:39], a[84:87], a[172:175], v[36:39]
    v_mfma_f32_16x16x32_bf16 v[24:27], a[88:91], a[168:171], v[24:27]
    v_mfma_f32_16x16x32_bf16 v[40:43], a[88:91], a[172:175], v[40:43]
    v_mfma_f32_16x16x32_bf16 v[28:31], a[92:95], a[168:171], v[28:31]
    v_mfma_f32_16x16x32_bf16 v[44:47], a[92:95], a[172:175], v[44:47]
    s_waitcnt vmcnt(9)
    v_mfma_f32_16x16x32_bf16 v[16:19], a[96:99], a[176:179], v[16:19]
    v_mfma_f32_16x16x32_bf16 v[32:35], a[96:99], a[180:183], v[32:35]
    v_mfma_f32_16x16x32_bf16 v[20:23], a[100:103], a[176:179], v[20:23]
    v_mfma_f32_16x16x32_bf16 v[36:39], a[100:103], a[180:183], v[36:39]
    v_mfma_f32_16x16x32_bf16 v[24:27], a[104:107], a[176:179], v[24:27]
    v_mfma_f32_16x16x32_bf16 v[40:43], a[104:107], a[180:183], v[40:43]
    v_mfma_f32_16x16x32_bf16 v[28:31], a[108:111], a[176:179], v[28:31]
    v_mfma_f32_16x16x32_bf16 v[44:47], a[108:111], a[180:183], v[44:47]
    buffer_load_dword v13, v12, s[68:71], 0 offen offset:128 sc1
    s_waitcnt vmcnt(4)
    v_mfma_f32_16x16x32_bf16 v[16:19], a[112:115], a[184:187], v[16:19]
    v_mfma_f32_16x16x32_bf16 v[32:35], a[112:115], a[188:191], v[32:35]
    v_mfma_f32_16x16x32_bf16 v[20:23], a[116:119], a[184:187], v[20:23]
    v_mfma_f32_16x16x32_bf16 v[36:39], a[116:119], a[188:191], v[36:39]
    v_mfma_f32_16x16x32_bf16 v[24:27], a[120:123], a[184:187], v[24:27]
    v_mfma_f32_16x16x32_bf16 v[40:43], a[120:123], a[188:191], v[40:43]
    v_mfma_f32_16x16x32_bf16 v[28:31], a[124:127], a[184:187], v[28:31]
    v_mfma_f32_16x16x32_bf16 v[44:47], a[124:127], a[188:191], v[44:47]
    s_waitcnt vmcnt(0)
    v_cmp_ne_u32 vcc, 8, v13
    s_nop 4
    s_cmp_eq_u64 vcc, 0
    s_cbranch_scc0 L_recurrent_scan__spectral_fnet__swiglu_ffn__prompt_kernel_late4_14
    buffer_load_dwordx4 v[64:67], v244, s[20:23], s72 offen sc1
    buffer_load_dwordx4 v[68:71], v244, s[20:23], s73 offen sc1
    buffer_load_dwordx4 v[72:75], v244, s[20:23], s74 offen sc1
    buffer_load_dwordx4 v[76:79], v244, s[20:23], s75 offen sc1
    buffer_load_dwordx4 v[80:83], v244, s[20:23], s76 offen sc1
    buffer_load_dwordx4 v[84:87], v244, s[20:23], s77 offen sc1
    buffer_load_dwordx4 v[88:91], v244, s[20:23], s78 offen sc1
    buffer_load_dwordx4 v[92:95], v244, s[20:23], s79 offen sc1
    buffer_load_dwordx4 v[96:99], v245, s[20:23], s72 offen sc1
    buffer_load_dwordx4 v[100:103], v245, s[20:23], s73 offen sc1
    buffer_load_dwordx4 v[104:107], v245, s[20:23], s74 offen sc1
    buffer_load_dwordx4 v[108:111], v245, s[20:23], s75 offen sc1
    buffer_load_dwordx4 v[112:115], v245, s[20:23], s76 offen sc1
    buffer_load_dwordx4 v[116:119], v245, s[20:23], s77 offen sc1
    buffer_load_dwordx4 v[120:123], v245, s[20:23], s78 offen sc1
    buffer_load_dwordx4 v[124:127], v245, s[20:23], s79 offen sc1
    buffer_load_dwordx4 v[128:131], v246, s[20:23], s72 offen sc1
    buffer_load_dwordx4 v[132:135], v246, s[20:23], s73 offen sc1
    buffer_load_dwordx4 v[136:139], v246, s[20:23], s74 offen sc1
    buffer_load_dwordx4 v[140:143], v246, s[20:23], s75 offen sc1
    buffer_load_dwordx4 v[144:147], v246, s[20:23], s76 offen sc1
    buffer_load_dwordx4 v[148:151], v246, s[20:23], s77 offen sc1
    buffer_load_dwordx4 v[152:155], v246, s[20:23], s78 offen sc1
    buffer_load_dwordx4 v[156:159], v246, s[20:23], s79 offen sc1
    ds_write_b128 v248, v[16:19] offset:0
    ds_write_b128 v248, v[20:23] offset:64
    ds_write_b128 v248, v[24:27] offset:128
    ds_write_b128 v248, v[28:31] offset:192
    ds_write_b128 v248, v[32:35] offset:4352
    ds_write_b128 v248, v[36:39] offset:4416
    ds_write_b128 v248, v[40:43] offset:4480
    ds_write_b128 v248, v[44:47] offset:4544
    s_waitcnt lgkmcnt(0)
    s_barrier
    s_branch L_recurrent_scan__spectral_fnet__swiglu_ffn__prompt_kernel_merge_13
L_recurrent_scan__spectral_fnet__swiglu_ffn__prompt_kernel_late4_14:
    s_nop 7
    ds_write_b128 v248, v[16:19] offset:0
    ds_write_b128 v248, v[20:23] offset:64
    ds_write_b128 v248, v[24:27] offset:128
    ds_write_b128 v248, v[28:31] offset:192
    ds_write_b128 v248, v[32:35] offset:4352
    ds_write_b128 v248, v[36:39] offset:4416
    ds_write_b128 v248, v[40:43] offset:4480
    ds_write_b128 v248, v[44:47] offset:4544
    s_cmp_lg_u32 s6, 0
    s_cbranch_scc1 L_recurrent_scan__spectral_fnet__swiglu_ffn__prompt_kernel_rdy_15
    s_movk_i32 s61, 4096
    s_waitcnt vmcnt(0)
L_recurrent_scan__spectral_fnet__swiglu_ffn__prompt_kernel_spin_16:
    v_cmp_ne_u32 vcc, 8, v13
    s_nop 4
    s_cmp_eq_u64 vcc, 0
    s_cbranch_scc1 L_recurrent_scan__spectral_fnet__swiglu_ffn__prompt_kernel_rdy_15
    buffer_load_dword v13, v12, s[68:71], 0 offen offset:128 sc1
    s_sub_u32 s61, s61, 1
    s_cmp_lg_u32 s61, 0
    s_waitcnt vmcnt(0)
    s_cbranch_scc1 L_recurrent_scan__spectral_fnet__swiglu_ffn__prompt_kernel_spin_16
L_recurrent_scan__spectral_fnet__swiglu_ffn__prompt_kernel_rdy_15:
    s_waitcnt lgkmcnt(0)
    s_barrier
    buffer_load_dwordx4 v[64:67], v244, s[20:23], s72 offen sc1
    buffer_load_dwordx4 v[68:71], v244, s[20:23], s73 offen sc1
    buffer_load_dwordx4 v[72:75], v244, s[20:23], s74 offen sc1
    buffer_load_dwordx4 v[76:79], v244, s[20:23], s75 offen sc1
    buffer_load_dwordx4 v[80:83], v244, s[20:23], s76 offen sc1
    buffer_load_dwordx4 v[84:87], v244, s[20:23], s77 offen sc1
    buffer_load_dwordx4 v[88:91], v244, s[20:23], s78 offen sc1
    buffer_load_dwordx4 v[92:95], v244, s[20:23], s79 offen sc1
    buffer_load_dwordx4 v[96:99], v245, s[20:23], s72 offen sc1
    buffer_load_dwordx4 v[100:103], v245, s[20:23], s73 offen sc1
    buffer_load_dwordx4 v[104:107], v245, s[20:23], s74 offen sc1
    buffer_load_dwordx4 v[108:111], v245, s[20:23], s75 offen sc1
    buffer_load_dwordx4 v[112:115], v245, s[20:23], s76 offen sc1
    buffer_load_dwordx4 v[116:119], v245, s[20:23], s77 offen sc1
    buffer_load_dwordx4 v[120:123], v245, s[20:23], s78 offen sc1
    buffer_load_dwordx4 v[124:127], v245, s[20:23], s79 offen sc1
    buffer_load_dwordx4 v[128:131], v246, s[20:23], s72 offen sc1
    buffer_load_dwordx4 v[132:135], v246, s[20:23], s73 offen sc1
    buffer_load_dwordx4 v[136:139], v246, s[20:23], s74 offen sc1
    buffer_load_dwordx4 v[140:143], v246, s[20:23], s75 offen sc1
    buffer_load_dwordx4 v[144:147], v246, s[20:23], s76 offen sc1
    buffer_load_dwordx4 v[148:151], v246, s[20:23], s77 offen sc1
    buffer_load_dwordx4 v[152:155], v246, s[20:23], s78 offen sc1
    buffer_load_dwordx4 v[156:159], v246, s[20:23], s79 offen sc1
L_recurrent_scan__spectral_fnet__swiglu_ffn__prompt_kernel_merge_13:
    s_cmp_eq_u32 s54, 1
    s_cbranch_scc1 L_recurrent_scan__spectral_fnet__swiglu_ffn__prompt_kernel_bwd_17
    ds_read_b128 v[172:175], v249 offset:0
    ds_read_b128 v[176:179], v249 offset:16
    ds_read_b128 v[196:199], v249 offset:17408
    ds_read_b128 v[200:203], v249 offset:17424
    ds_read_b128 v[184:187], v249 offset:8704
    ds_read_b128 v[188:191], v249 offset:8720
    ds_read_b128 v[208:211], v249 offset:26112
    ds_read_b128 v[212:215], v249 offset:26128
    s_waitcnt vmcnt(23)
    v_dot2_f32_bf16 v228, v64, s36, 0
    v_dot2_f32_bf16 v229, v64, s37, 0
    v_dot2_f32_bf16 v230, v65, s36, 0
    v_dot2_f32_bf16 v231, v65, s37, 0
    v_dot2_f32_bf16 v232, v66, s36, 0
    v_dot2_f32_bf16 v233, v66, s37, 0
    v_dot2_f32_bf16 v234, v67, s36, 0
    v_dot2_f32_bf16 v235, v67, s37, 0
    s_waitcnt vmcnt(22)
    v_dot2_f32_bf16 v228, v68, s36, v228
    v_dot2_f32_bf16 v229, v68, s37, v229
    v_dot2_f32_bf16 v230, v69, s36, v230
    v_dot2_f32_bf16 v231, v69, s37, v231
    v_dot2_f32_bf16 v232, v70, s36, v232
    v_dot2_f32_bf16 v233, v70, s37, v233
    v_dot2_f32_bf16 v234, v71, s36, v234
    v_dot2_f32_bf16 v235, v71, s37, v235
    s_waitcnt vmcnt(21)
    v_dot2_f32_bf16 v228, v72, s36, v228
    v_dot2_f32_bf16 v229, v72, s37, v229
    v_dot2_f32_bf16 v230, v73, s36, v230
    v_dot2_f32_bf16 v231, v73, s37, v231
    v_dot2_f32_bf16 v232, v74, s36, v232
    v_dot2_f32_bf16 v233, v74, s37, v233
    v_dot2_f32_bf16 v234, v75, s36, v234
    v_dot2_f32_bf16 v235, v75, s37, v235
    s_waitcnt vmcnt(20)
    v_dot2_f32_bf16 v228, v76, s36, v228
    v_dot2_f32_bf16 v229, v76, s37, v229
    v_dot2_f32_bf16 v230, v77, s36, v230
    v_dot2_f32_bf16 v231, v77, s37, v231
    v_dot2_f32_bf16 v232, v78, s36, v232
    v_dot2_f32_bf16 v233, v78, s37, v233
    v_dot2_f32_bf16 v234, v79, s36, v234
    v_dot2_f32_bf16 v235, v79, s37, v235
    s_waitcnt vmcnt(19)
    v_dot2_f32_bf16 v228, v80, s36, v228
    v_dot2_f32_bf16 v229, v80, s37, v229
    v_dot2_f32_bf16 v230, v81, s36, v230
    v_dot2_f32_bf16 v231, v81, s37, v231
    v_dot2_f32_bf16 v232, v82, s36, v232
    v_dot2_f32_bf16 v233, v82, s37, v233
    v_dot2_f32_bf16 v234, v83, s36, v234
    v_dot2_f32_bf16 v235, v83, s37, v235
    s_waitcnt vmcnt(18)
    v_dot2_f32_bf16 v228, v84, s36, v228
    v_dot2_f32_bf16 v229, v84, s37, v229
    v_dot2_f32_bf16 v230, v85, s36, v230
    v_dot2_f32_bf16 v231, v85, s37, v231
    v_dot2_f32_bf16 v232, v86, s36, v232
    v_dot2_f32_bf16 v233, v86, s37, v233
    v_dot2_f32_bf16 v234, v87, s36, v234
    v_dot2_f32_bf16 v235, v87, s37, v235
    s_waitcnt vmcnt(17)
    v_dot2_f32_bf16 v228, v88, s36, v228
    v_dot2_f32_bf16 v229, v88, s37, v229
    v_dot2_f32_bf16 v230, v89, s36, v230
    v_dot2_f32_bf16 v231, v89, s37, v231
    v_dot2_f32_bf16 v232, v90, s36, v232
    v_dot2_f32_bf16 v233, v90, s37, v233
    v_dot2_f32_bf16 v234, v91, s36, v234
    v_dot2_f32_bf16 v235, v91, s37, v235
    s_waitcnt vmcnt(16)
    v_dot2_f32_bf16 v228, v92, s36, v228
    v_dot2_f32_bf16 v229, v92, s37, v229
    v_dot2_f32_bf16 v230, v93, s36, v230
    v_dot2_f32_bf16 v231, v93, s37, v231
    v_dot2_f32_bf16 v232, v94, s36, v232
    v_dot2_f32_bf16 v233, v94, s37, v233
    v_dot2_f32_bf16 v234, v95, s36, v234
    v_dot2_f32_bf16 v235, v95, s37, v235
    s_waitcnt lgkmcnt(4)
    v_add_f32 v220, v172, v196
    v_add_f32 v221, v173, v197
    v_add_f32 v222, v174, v198
    v_add_f32 v223, v175, v199
    v_add_f32 v224, v176, v200
    v_add_f32 v225, v177, v201
    v_add_f32 v226, v178, v202
    v_add_f32 v227, v179, v203
    s_waitcnt lgkmcnt(0)
    v_add_f32 v236, v184, v208
    v_add_f32 v237, v185, v209
    v_add_f32 v238, v186, v210
    v_add_f32 v239, v187, v211
    v_add_f32 v240, v188, v212
    v_add_f32 v241, v189, v213
    v_add_f32 v242, v190, v214
    v_add_f32 v243, v191, v215
    v_fma_f32 v220, v236, s33, v220
    v_fma_f32 v221, v237, s33, v221
    v_fma_f32 v222, v238, s33, v222
    v_fma_f32 v223, v239, s33, v223
    v_fma_f32 v224, v240, s33, v224
    v_fma_f32 v225, v241, s33, v225
    v_fma_f32 v226, v242, s33, v226
    v_fma_f32 v227, v243, s33, v227
    v_exp_f32 v236, -v228
    v_exp_f32 v237, -v229
    v_exp_f32 v238, -v230
    v_exp_f32 v239, -v231
    v_exp_f32 v240, -v232
    v_exp_f32 v241, -v233
    v_exp_f32 v242, -v234
    v_exp_f32 v243, -v235
    v_pk_mul_f32 v[220:221], v[220:221], v[228:229]
    v_pk_mul_f32 v[222:223], v[222:223], v[230:231]
    v_pk_mul_f32 v[224:225], v[224:225], v[232:233]
    v_pk_mul_f32 v[226:227], v[226:227], v[234:235]
    v_fma_f32 v236, v236, s38, s38
    v_fma_f32 v237, v237, s38, s38
    v_fma_f32 v238, v238, s38, s38
    v_fma_f32 v239, v239, s38, s38
    v_fma_f32 v240, v240, s38, s38
    v_fma_f32 v241, v241, s38, s38
    v_fma_f32 v242, v242, s38, s38
    v_fma_f32 v243, v243, s38, s38
    v_rcp_f32 v236, v236
    v_rcp_f32 v237, v237
    v_rcp_f32 v238, v238
    v_rcp_f32 v239, v239
    v_rcp_f32 v240, v240
    v_rcp_f32 v241, v241
    v_rcp_f32 v242, v242
    v_rcp_f32 v243, v243
    s_nop 0
    v_pk_mul_f32 v[220:221], v[220:221], v[236:237]
    v_pk_mul_f32 v[222:223], v[222:223], v[238:239]
    v_pk_mul_f32 v[224:225], v[224:225], v[240:241]
    v_pk_mul_f32 v[226:227], v[226:227], v[242:243]
    s_waitcnt vmcnt(27)
    v_dot2_f32_bf16 v220, v160, s36, v220
    v_dot2_f32_bf16 v221, v160, s37, v221
    v_dot2_f32_bf16 v222, v161, s36, v222
    v_dot2_f32_bf16 v223, v161, s37, v223
    v_dot2_f32_bf16 v224, v162, s36, v224
    v_dot2_f32_bf16 v225, v162, s37, v225
    v_dot2_f32_bf16 v226, v163, s36, v226
    v_dot2_f32_bf16 v227, v163, s37, v227
    v_cvt_pk_bf16_f32 v160, v220, v221
    v_cvt_pk_bf16_f32 v161, v222, v223
    v_cvt_pk_bf16_f32 v162, v224, v225
    v_cvt_pk_bf16_f32 v163, v226, v227
    buffer_store_dwordx4 v[160:163], v247, s[12:15], 0 offen offset:0
    ds_read_b128 v[172:175], v249 offset:64
    ds_read_b128 v[176:179], v249 offset:80
    ds_read_b128 v[196:199], v249 offset:17472
    ds_read_b128 v[200:203], v249 offset:17488
    ds_read_b128 v[184:187], v249 offset:8768
    ds_read_b128 v[188:191], v249 offset:8784
    ds_read_b128 v[208:211], v249 offset:26176
    ds_read_b128 v[212:215], v249 offset:26192
    s_waitcnt vmcnt(16)
    v_dot2_f32_bf16 v228, v96, s36, 0
    v_dot2_f32_bf16 v229, v96, s37, 0
    v_dot2_f32_bf16 v230, v97, s36, 0
    v_dot2_f32_bf16 v231, v97, s37, 0
    v_dot2_f32_bf16 v232, v98, s36, 0
    v_dot2_f32_bf16 v233, v98, s37, 0
    v_dot2_f32_bf16 v234, v99, s36, 0
    v_dot2_f32_bf16 v235, v99, s37, 0
    s_waitcnt vmcnt(15)
    v_dot2_f32_bf16 v228, v100, s36, v228
    v_dot2_f32_bf16 v229, v100, s37, v229
    v_dot2_f32_bf16 v230, v101, s36, v230
    v_dot2_f32_bf16 v231, v101, s37, v231
    v_dot2_f32_bf16 v232, v102, s36, v232
    v_dot2_f32_bf16 v233, v102, s37, v233
    v_dot2_f32_bf16 v234, v103, s36, v234
    v_dot2_f32_bf16 v235, v103, s37, v235
    s_waitcnt vmcnt(14)
    v_dot2_f32_bf16 v228, v104, s36, v228
    v_dot2_f32_bf16 v229, v104, s37, v229
    v_dot2_f32_bf16 v230, v105, s36, v230
    v_dot2_f32_bf16 v231, v105, s37, v231
    v_dot2_f32_bf16 v232, v106, s36, v232
    v_dot2_f32_bf16 v233, v106, s37, v233
    v_dot2_f32_bf16 v234, v107, s36, v234
    v_dot2_f32_bf16 v235, v107, s37, v235
    s_waitcnt vmcnt(13)
    v_dot2_f32_bf16 v228, v108, s36, v228
    v_dot2_f32_bf16 v229, v108, s37, v229
    v_dot2_f32_bf16 v230, v109, s36, v230
    v_dot2_f32_bf16 v231, v109, s37, v231
    v_dot2_f32_bf16 v232, v110, s36, v232
    v_dot2_f32_bf16 v233, v110, s37, v233
    v_dot2_f32_bf16 v234, v111, s36, v234
    v_dot2_f32_bf16 v235, v111, s37, v235
    s_waitcnt vmcnt(12)
    v_dot2_f32_bf16 v228, v112, s36, v228
    v_dot2_f32_bf16 v229, v112, s37, v229
    v_dot2_f32_bf16 v230, v113, s36, v230
    v_dot2_f32_bf16 v231, v113, s37, v231
    v_dot2_f32_bf16 v232, v114, s36, v232
    v_dot2_f32_bf16 v233, v114, s37, v233
    v_dot2_f32_bf16 v234, v115, s36, v234
    v_dot2_f32_bf16 v235, v115, s37, v235
    s_waitcnt vmcnt(11)
    v_dot2_f32_bf16 v228, v116, s36, v228
    v_dot2_f32_bf16 v229, v116, s37, v229
    v_dot2_f32_bf16 v230, v117, s36, v230
    v_dot2_f32_bf16 v231, v117, s37, v231
    v_dot2_f32_bf16 v232, v118, s36, v232
    v_dot2_f32_bf16 v233, v118, s37, v233
    v_dot2_f32_bf16 v234, v119, s36, v234
    v_dot2_f32_bf16 v235, v119, s37, v235
    s_waitcnt vmcnt(10)
    v_dot2_f32_bf16 v228, v120, s36, v228
    v_dot2_f32_bf16 v229, v120, s37, v229
    v_dot2_f32_bf16 v230, v121, s36, v230
    v_dot2_f32_bf16 v231, v121, s37, v231
    v_dot2_f32_bf16 v232, v122, s36, v232
    v_dot2_f32_bf16 v233, v122, s37, v233
    v_dot2_f32_bf16 v234, v123, s36, v234
    v_dot2_f32_bf16 v235, v123, s37, v235
    s_waitcnt vmcnt(9)
    v_dot2_f32_bf16 v228, v124, s36, v228
    v_dot2_f32_bf16 v229, v124, s37, v229
    v_dot2_f32_bf16 v230, v125, s36, v230
    v_dot2_f32_bf16 v231, v125, s37, v231
    v_dot2_f32_bf16 v232, v126, s36, v232
    v_dot2_f32_bf16 v233, v126, s37, v233
    v_dot2_f32_bf16 v234, v127, s36, v234
    v_dot2_f32_bf16 v235, v127, s37, v235
    s_waitcnt lgkmcnt(4)
    v_add_f32 v220, v172, v196
    v_add_f32 v221, v173, v197
    v_add_f32 v222, v174, v198
    v_add_f32 v223, v175, v199
    v_add_f32 v224, v176, v200
    v_add_f32 v225, v177, v201
    v_add_f32 v226, v178, v202
    v_add_f32 v227, v179, v203
    s_waitcnt lgkmcnt(0)
    v_add_f32 v236, v184, v208
    v_add_f32 v237, v185, v209
    v_add_f32 v238, v186, v210
    v_add_f32 v239, v187, v211
    v_add_f32 v240, v188, v212
    v_add_f32 v241, v189, v213
    v_add_f32 v242, v190, v214
    v_add_f32 v243, v191, v215
    v_fma_f32 v220, v236, s33, v220
    v_fma_f32 v221, v237, s33, v221
    v_fma_f32 v222, v238, s33, v222
    v_fma_f32 v223, v239, s33, v223
    v_fma_f32 v224, v240, s33, v224
    v_fma_f32 v225, v241, s33, v225
    v_fma_f32 v226, v242, s33, v226
    v_fma_f32 v227, v243, s33, v227
    v_exp_f32 v236, -v228
    v_exp_f32 v237, -v229
    v_exp_f32 v238, -v230
    v_exp_f32 v239, -v231
    v_exp_f32 v240, -v232
    v_exp_f32 v241, -v233
    v_exp_f32 v242, -v234
    v_exp_f32 v243, -v235
    v_pk_mul_f32 v[220:221], v[220:221], v[228:229]
    v_pk_mul_f32 v[222:223], v[222:223], v[230:231]
    v_pk_mul_f32 v[224:225], v[224:225], v[232:233]
    v_pk_mul_f32 v[226:227], v[226:227], v[234:235]
    v_fma_f32 v236, v236, s38, s38
    v_fma_f32 v237, v237, s38, s38
    v_fma_f32 v238, v238, s38, s38
    v_fma_f32 v239, v239, s38, s38
    v_fma_f32 v240, v240, s38, s38
    v_fma_f32 v241, v241, s38, s38
    v_fma_f32 v242, v242, s38, s38
    v_fma_f32 v243, v243, s38, s38
    v_rcp_f32 v236, v236
    v_rcp_f32 v237, v237
    v_rcp_f32 v238, v238
    v_rcp_f32 v239, v239
    v_rcp_f32 v240, v240
    v_rcp_f32 v241, v241
    v_rcp_f32 v242, v242
    v_rcp_f32 v243, v243
    s_nop 0
    v_pk_mul_f32 v[220:221], v[220:221], v[236:237]
    v_pk_mul_f32 v[222:223], v[222:223], v[238:239]
    v_pk_mul_f32 v[224:225], v[224:225], v[240:241]
    v_pk_mul_f32 v[226:227], v[226:227], v[242:243]
    s_waitcnt vmcnt(27)
    v_dot2_f32_bf16 v220, v164, s36, v220
    v_dot2_f32_bf16 v221, v164, s37, v221
    v_dot2_f32_bf16 v222, v165, s36, v222
    v_dot2_f32_bf16 v223, v165, s37, v223
    v_dot2_f32_bf16 v224, v166, s36, v224
    v_dot2_f32_bf16 v225, v166, s37, v225
    v_dot2_f32_bf16 v226, v167, s36, v226
    v_dot2_f32_bf16 v227, v167, s37, v227
    v_cvt_pk_bf16_f32 v164, v220, v221
    v_cvt_pk_bf16_f32 v165, v222, v223
    v_cvt_pk_bf16_f32 v166, v224, v225
    v_cvt_pk_bf16_f32 v167, v226, v227
    buffer_store_dwordx4 v[164:167], v247, s[12:15], 0 offen offset:32
    ds_read_b128 v[172:175], v249 offset:128
    ds_read_b128 v[176:179], v249 offset:144
    ds_read_b128 v[196:199], v249 offset:17536
    ds_read_b128 v[200:203], v249 offset:17552
    ds_read_b128 v[184:187], v249 offset:8832
    ds_read_b128 v[188:191], v249 offset:8848
    ds_read_b128 v[208:211], v249 offset:26240
    ds_read_b128 v[212:215], v249 offset:26256
    s_waitcnt vmcnt(9)
    v_dot2_f32_bf16 v228, v128, s36, 0
    v_dot2_f32_bf16 v229, v128, s37, 0
    v_dot2_f32_bf16 v230, v129, s36, 0
    v_dot2_f32_bf16 v231, v129, s37, 0
    v_dot2_f32_bf16 v232, v130, s36, 0
    v_dot2_f32_bf16 v233, v130, s37, 0
    v_dot2_f32_bf16 v234, v131, s36, 0
    v_dot2_f32_bf16 v235, v131, s37, 0
    s_waitcnt vmcnt(8)
    v_dot2_f32_bf16 v228, v132, s36, v228
    v_dot2_f32_bf16 v229, v132, s37, v229
    v_dot2_f32_bf16 v230, v133, s36, v230
    v_dot2_f32_bf16 v231, v133, s37, v231
    v_dot2_f32_bf16 v232, v134, s36, v232
    v_dot2_f32_bf16 v233, v134, s37, v233
    v_dot2_f32_bf16 v234, v135, s36, v234
    v_dot2_f32_bf16 v235, v135, s37, v235
    s_waitcnt vmcnt(7)
    v_dot2_f32_bf16 v228, v136, s36, v228
    v_dot2_f32_bf16 v229, v136, s37, v229
    v_dot2_f32_bf16 v230, v137, s36, v230
    v_dot2_f32_bf16 v231, v137, s37, v231
    v_dot2_f32_bf16 v232, v138, s36, v232
    v_dot2_f32_bf16 v233, v138, s37, v233
    v_dot2_f32_bf16 v234, v139, s36, v234
    v_dot2_f32_bf16 v235, v139, s37, v235
    s_waitcnt vmcnt(6)
    v_dot2_f32_bf16 v228, v140, s36, v228
    v_dot2_f32_bf16 v229, v140, s37, v229
    v_dot2_f32_bf16 v230, v141, s36, v230
    v_dot2_f32_bf16 v231, v141, s37, v231
    v_dot2_f32_bf16 v232, v142, s36, v232
    v_dot2_f32_bf16 v233, v142, s37, v233
    v_dot2_f32_bf16 v234, v143, s36, v234
    v_dot2_f32_bf16 v235, v143, s37, v235
    s_waitcnt vmcnt(5)
    v_dot2_f32_bf16 v228, v144, s36, v228
    v_dot2_f32_bf16 v229, v144, s37, v229
    v_dot2_f32_bf16 v230, v145, s36, v230
    v_dot2_f32_bf16 v231, v145, s37, v231
    v_dot2_f32_bf16 v232, v146, s36, v232
    v_dot2_f32_bf16 v233, v146, s37, v233
    v_dot2_f32_bf16 v234, v147, s36, v234
    v_dot2_f32_bf16 v235, v147, s37, v235
    s_waitcnt vmcnt(4)
    v_dot2_f32_bf16 v228, v148, s36, v228
    v_dot2_f32_bf16 v229, v148, s37, v229
    v_dot2_f32_bf16 v230, v149, s36, v230
    v_dot2_f32_bf16 v231, v149, s37, v231
    v_dot2_f32_bf16 v232, v150, s36, v232
    v_dot2_f32_bf16 v233, v150, s37, v233
    v_dot2_f32_bf16 v234, v151, s36, v234
    v_dot2_f32_bf16 v235, v151, s37, v235
    s_waitcnt vmcnt(3)
    v_dot2_f32_bf16 v228, v152, s36, v228
    v_dot2_f32_bf16 v229, v152, s37, v229
    v_dot2_f32_bf16 v230, v153, s36, v230
    v_dot2_f32_bf16 v231, v153, s37, v231
    v_dot2_f32_bf16 v232, v154, s36, v232
    v_dot2_f32_bf16 v233, v154, s37, v233
    v_dot2_f32_bf16 v234, v155, s36, v234
    v_dot2_f32_bf16 v235, v155, s37, v235
    s_waitcnt vmcnt(2)
    v_dot2_f32_bf16 v228, v156, s36, v228
    v_dot2_f32_bf16 v229, v156, s37, v229
    v_dot2_f32_bf16 v230, v157, s36, v230
    v_dot2_f32_bf16 v231, v157, s37, v231
    v_dot2_f32_bf16 v232, v158, s36, v232
    v_dot2_f32_bf16 v233, v158, s37, v233
    v_dot2_f32_bf16 v234, v159, s36, v234
    v_dot2_f32_bf16 v235, v159, s37, v235
    s_waitcnt lgkmcnt(4)
    v_add_f32 v220, v172, v196
    v_add_f32 v221, v173, v197
    v_add_f32 v222, v174, v198
    v_add_f32 v223, v175, v199
    v_add_f32 v224, v176, v200
    v_add_f32 v225, v177, v201
    v_add_f32 v226, v178, v202
    v_add_f32 v227, v179, v203
    s_waitcnt lgkmcnt(0)
    v_add_f32 v236, v184, v208
    v_add_f32 v237, v185, v209
    v_add_f32 v238, v186, v210
    v_add_f32 v239, v187, v211
    v_add_f32 v240, v188, v212
    v_add_f32 v241, v189, v213
    v_add_f32 v242, v190, v214
    v_add_f32 v243, v191, v215
    v_fma_f32 v220, v236, s33, v220
    v_fma_f32 v221, v237, s33, v221
    v_fma_f32 v222, v238, s33, v222
    v_fma_f32 v223, v239, s33, v223
    v_fma_f32 v224, v240, s33, v224
    v_fma_f32 v225, v241, s33, v225
    v_fma_f32 v226, v242, s33, v226
    v_fma_f32 v227, v243, s33, v227
    v_exp_f32 v236, -v228
    v_exp_f32 v237, -v229
    v_exp_f32 v238, -v230
    v_exp_f32 v239, -v231
    v_exp_f32 v240, -v232
    v_exp_f32 v241, -v233
    v_exp_f32 v242, -v234
    v_exp_f32 v243, -v235
    v_pk_mul_f32 v[220:221], v[220:221], v[228:229]
    v_pk_mul_f32 v[222:223], v[222:223], v[230:231]
    v_pk_mul_f32 v[224:225], v[224:225], v[232:233]
    v_pk_mul_f32 v[226:227], v[226:227], v[234:235]
    v_fma_f32 v236, v236, s38, s38
    v_fma_f32 v237, v237, s38, s38
    v_fma_f32 v238, v238, s38, s38
    v_fma_f32 v239, v239, s38, s38
    v_fma_f32 v240, v240, s38, s38
    v_fma_f32 v241, v241, s38, s38
    v_fma_f32 v242, v242, s38, s38
    v_fma_f32 v243, v243, s38, s38
    v_rcp_f32 v236, v236
    v_rcp_f32 v237, v237
    v_rcp_f32 v238, v238
    v_rcp_f32 v239, v239
    v_rcp_f32 v240, v240
    v_rcp_f32 v241, v241
    v_rcp_f32 v242, v242
    v_rcp_f32 v243, v243
    s_nop 0
    v_pk_mul_f32 v[220:221], v[220:221], v[236:237]
    v_pk_mul_f32 v[222:223], v[222:223], v[238:239]
    v_pk_mul_f32 v[224:225], v[224:225], v[240:241]
    v_pk_mul_f32 v[226:227], v[226:227], v[242:243]
    s_waitcnt vmcnt(27)
    v_dot2_f32_bf16 v220, v168, s36, v220
    v_dot2_f32_bf16 v221, v168, s37, v221
    v_dot2_f32_bf16 v222, v169, s36, v222
    v_dot2_f32_bf16 v223, v169, s37, v223
    v_dot2_f32_bf16 v224, v170, s36, v224
    v_dot2_f32_bf16 v225, v170, s37, v225
    v_dot2_f32_bf16 v226, v171, s36, v226
    v_dot2_f32_bf16 v227, v171, s37, v227
    v_cvt_pk_bf16_f32 v168, v220, v221
    v_cvt_pk_bf16_f32 v169, v222, v223
    v_cvt_pk_bf16_f32 v170, v224, v225
    v_cvt_pk_bf16_f32 v171, v226, v227
    buffer_store_dwordx4 v[168:171], v247, s[12:15], 0 offen offset:64
    s_branch L_recurrent_scan__spectral_fnet__swiglu_ffn__prompt_kernel_done_18
L_recurrent_scan__spectral_fnet__swiglu_ffn__prompt_kernel_bwd_17:
    ds_read_b128 v[172:175], v249 offset:128
    ds_read_b128 v[176:179], v249 offset:144
    ds_read_b128 v[180:183], v249 offset:160
    ds_read_b128 v[196:199], v249 offset:17536
    ds_read_b128 v[200:203], v249 offset:17552
    ds_read_b128 v[204:207], v249 offset:17568
    ds_read_b128 v[184:187], v249 offset:8832
    ds_read_b128 v[188:191], v249 offset:8848
    ds_read_b128 v[192:195], v249 offset:8864
    ds_read_b128 v[208:211], v249 offset:26240
    ds_read_b128 v[212:215], v249 offset:26256
    ds_read_b128 v[216:219], v249 offset:26272
    s_waitcnt vmcnt(23)
    v_dot2_f32_bf16 v228, v64, s36, 0
    v_dot2_f32_bf16 v229, v64, s37, 0
    v_dot2_f32_bf16 v230, v65, s36, 0
    v_dot2_f32_bf16 v231, v65, s37, 0
    v_dot2_f32_bf16 v232, v66, s36, 0
    v_dot2_f32_bf16 v233, v66, s37, 0
    v_dot2_f32_bf16 v234, v67, s36, 0
    v_dot2_f32_bf16 v235, v67, s37, 0
    s_waitcnt vmcnt(22)
    v_dot2_f32_bf16 v228, v68, s36, v228
    v_dot2_f32_bf16 v229, v68, s37, v229
    v_dot2_f32_bf16 v230, v69, s36, v230
    v_dot2_f32_bf16 v231, v69, s37, v231
    v_dot2_f32_bf16 v232, v70, s36, v232
    v_dot2_f32_bf16 v233, v70, s37, v233
    v_dot2_f32_bf16 v234, v71, s36, v234
    v_dot2_f32_bf16 v235, v71, s37, v235
    s_waitcnt vmcnt(21)
    v_dot2_f32_bf16 v228, v72, s36, v228
    v_dot2_f32_bf16 v229, v72, s37, v229
    v_dot2_f32_bf16 v230, v73, s36, v230
    v_dot2_f32_bf16 v231, v73, s37, v231
    v_dot2_f32_bf16 v232, v74, s36, v232
    v_dot2_f32_bf16 v233, v74, s37, v233
    v_dot2_f32_bf16 v234, v75, s36, v234
    v_dot2_f32_bf16 v235, v75, s37, v235
    s_waitcnt vmcnt(20)
    v_dot2_f32_bf16 v228, v76, s36, v228
    v_dot2_f32_bf16 v229, v76, s37, v229
    v_dot2_f32_bf16 v230, v77, s36, v230
    v_dot2_f32_bf16 v231, v77, s37, v231
    v_dot2_f32_bf16 v232, v78, s36, v232
    v_dot2_f32_bf16 v233, v78, s37, v233
    v_dot2_f32_bf16 v234, v79, s36, v234
    v_dot2_f32_bf16 v235, v79, s37, v235
    s_waitcnt vmcnt(19)
    v_dot2_f32_bf16 v228, v80, s36, v228
    v_dot2_f32_bf16 v229, v80, s37, v229
    v_dot2_f32_bf16 v230, v81, s36, v230
    v_dot2_f32_bf16 v231, v81, s37, v231
    v_dot2_f32_bf16 v232, v82, s36, v232
    v_dot2_f32_bf16 v233, v82, s37, v233
    v_dot2_f32_bf16 v234, v83, s36, v234
    v_dot2_f32_bf16 v235, v83, s37, v235
    s_waitcnt vmcnt(18)
    v_dot2_f32_bf16 v228, v84, s36, v228
    v_dot2_f32_bf16 v229, v84, s37, v229
    v_dot2_f32_bf16 v230, v85, s36, v230
    v_dot2_f32_bf16 v231, v85, s37, v231
    v_dot2_f32_bf16 v232, v86, s36, v232
    v_dot2_f32_bf16 v233, v86, s37, v233
    v_dot2_f32_bf16 v234, v87, s36, v234
    v_dot2_f32_bf16 v235, v87, s37, v235
    s_waitcnt vmcnt(17)
    v_dot2_f32_bf16 v228, v88, s36, v228
    v_dot2_f32_bf16 v229, v88, s37, v229
    v_dot2_f32_bf16 v230, v89, s36, v230
    v_dot2_f32_bf16 v231, v89, s37, v231
    v_dot2_f32_bf16 v232, v90, s36, v232
    v_dot2_f32_bf16 v233, v90, s37, v233
    v_dot2_f32_bf16 v234, v91, s36, v234
    v_dot2_f32_bf16 v235, v91, s37, v235
    s_waitcnt vmcnt(16)
    v_dot2_f32_bf16 v228, v92, s36, v228
    v_dot2_f32_bf16 v229, v92, s37, v229
    v_dot2_f32_bf16 v230, v93, s36, v230
    v_dot2_f32_bf16 v231, v93, s37, v231
    v_dot2_f32_bf16 v232, v94, s36, v232
    v_dot2_f32_bf16 v233, v94, s37, v233
    v_dot2_f32_bf16 v234, v95, s36, v234
    v_dot2_f32_bf16 v235, v95, s37, v235
    s_waitcnt lgkmcnt(6)
    v_add_f32 v220, v180, v204
    v_add_f32 v221, v179, v203
    v_add_f32 v222, v178, v202
    v_add_f32 v223, v177, v201
    v_add_f32 v224, v176, v200
    v_add_f32 v225, v175, v199
    v_add_f32 v226, v174, v198
    v_add_f32 v227, v173, v197
    s_waitcnt lgkmcnt(0)
    v_add_f32 v236, v192, v216
    v_add_f32 v237, v191, v215
    v_add_f32 v238, v190, v214
    v_add_f32 v239, v189, v213
    v_add_f32 v240, v188, v212
    v_add_f32 v241, v187, v211
    v_add_f32 v242, v186, v210
    v_add_f32 v243, v185, v209
    v_fma_f32 v220, v236, s33, v220
    v_fma_f32 v221, v237, s33, v221
    v_fma_f32 v222, v238, s33, v222
    v_fma_f32 v223, v239, s33, v223
    v_fma_f32 v224, v240, s33, v224
    v_fma_f32 v225, v241, s33, v225
    v_fma_f32 v226, v242, s33, v226
    v_fma_f32 v227, v243, s33, v227
    v_exp_f32 v236, -v228
    v_exp_f32 v237, -v229
    v_exp_f32 v238, -v230
    v_exp_f32 v239, -v231
    v_exp_f32 v240, -v232
    v_exp_f32 v241, -v233
    v_exp_f32 v242, -v234
    v_exp_f32 v243, -v235
    v_pk_mul_f32 v[220:221], v[220:221], v[228:229]
    v_pk_mul_f32 v[222:223], v[222:223], v[230:231]
    v_pk_mul_f32 v[224:225], v[224:225], v[232:233]
    v_pk_mul_f32 v[226:227], v[226:227], v[234:235]
    v_fma_f32 v236, v236, s38, s38
    v_fma_f32 v237, v237, s38, s38
    v_fma_f32 v238, v238, s38, s38
    v_fma_f32 v239, v239, s38, s38
    v_fma_f32 v240, v240, s38, s38
    v_fma_f32 v241, v241, s38, s38
    v_fma_f32 v242, v242, s38, s38
    v_fma_f32 v243, v243, s38, s38
    v_rcp_f32 v236, v236
    v_rcp_f32 v237, v237
    v_rcp_f32 v238, v238
    v_rcp_f32 v239, v239
    v_rcp_f32 v240, v240
    v_rcp_f32 v241, v241
    v_rcp_f32 v242, v242
    v_rcp_f32 v243, v243
    s_nop 0
    v_pk_mul_f32 v[220:221], v[220:221], v[236:237]
    v_pk_mul_f32 v[222:223], v[222:223], v[238:239]
    v_pk_mul_f32 v[224:225], v[224:225], v[240:241]
    v_pk_mul_f32 v[226:227], v[226:227], v[242:243]
    s_waitcnt vmcnt(27)
    v_dot2_f32_bf16 v220, v160, s36, v220
    v_dot2_f32_bf16 v221, v160, s37, v221
    v_dot2_f32_bf16 v222, v161, s36, v222
    v_dot2_f32_bf16 v223, v161, s37, v223
    v_dot2_f32_bf16 v224, v162, s36, v224
    v_dot2_f32_bf16 v225, v162, s37, v225
    v_dot2_f32_bf16 v226, v163, s36, v226
    v_dot2_f32_bf16 v227, v163, s37, v227
    v_cvt_pk_bf16_f32 v160, v220, v221
    v_cvt_pk_bf16_f32 v161, v222, v223
    v_cvt_pk_bf16_f32 v162, v224, v225
    v_cvt_pk_bf16_f32 v163, v226, v227
    buffer_store_dwordx4 v[160:163], v247, s[12:15], 0 offen offset:0
    ds_read_b128 v[172:175], v249 offset:64
    ds_read_b128 v[176:179], v249 offset:80
    ds_read_b128 v[180:183], v249 offset:96
    ds_read_b128 v[196:199], v249 offset:17472
    ds_read_b128 v[200:203], v249 offset:17488
    ds_read_b128 v[204:207], v249 offset:17504
    ds_read_b128 v[184:187], v249 offset:8768
    ds_read_b128 v[188:191], v249 offset:8784
    ds_read_b128 v[192:195], v249 offset:8800
    ds_read_b128 v[208:211], v249 offset:26176
    ds_read_b128 v[212:215], v249 offset:26192
    ds_read_b128 v[216:219], v249 offset:26208
    s_waitcnt vmcnt(16)
    v_dot2_f32_bf16 v228, v96, s36, 0
    v_dot2_f32_bf16 v229, v96, s37, 0
    v_dot2_f32_bf16 v230, v97, s36, 0
    v_dot2_f32_bf16 v231, v97, s37, 0
    v_dot2_f32_bf16 v232, v98, s36, 0
    v_dot2_f32_bf16 v233, v98, s37, 0
    v_dot2_f32_bf16 v234, v99, s36, 0
    v_dot2_f32_bf16 v235, v99, s37, 0
    s_waitcnt vmcnt(15)
    v_dot2_f32_bf16 v228, v100, s36, v228
    v_dot2_f32_bf16 v229, v100, s37, v229
    v_dot2_f32_bf16 v230, v101, s36, v230
    v_dot2_f32_bf16 v231, v101, s37, v231
    v_dot2_f32_bf16 v232, v102, s36, v232
    v_dot2_f32_bf16 v233, v102, s37, v233
    v_dot2_f32_bf16 v234, v103, s36, v234
    v_dot2_f32_bf16 v235, v103, s37, v235
    s_waitcnt vmcnt(14)
    v_dot2_f32_bf16 v228, v104, s36, v228
    v_dot2_f32_bf16 v229, v104, s37, v229
    v_dot2_f32_bf16 v230, v105, s36, v230
    v_dot2_f32_bf16 v231, v105, s37, v231
    v_dot2_f32_bf16 v232, v106, s36, v232
    v_dot2_f32_bf16 v233, v106, s37, v233
    v_dot2_f32_bf16 v234, v107, s36, v234
    v_dot2_f32_bf16 v235, v107, s37, v235
    s_waitcnt vmcnt(13)
    v_dot2_f32_bf16 v228, v108, s36, v228
    v_dot2_f32_bf16 v229, v108, s37, v229
    v_dot2_f32_bf16 v230, v109, s36, v230
    v_dot2_f32_bf16 v231, v109, s37, v231
    v_dot2_f32_bf16 v232, v110, s36, v232
    v_dot2_f32_bf16 v233, v110, s37, v233
    v_dot2_f32_bf16 v234, v111, s36, v234
    v_dot2_f32_bf16 v235, v111, s37, v235
    s_waitcnt vmcnt(12)
    v_dot2_f32_bf16 v228, v112, s36, v228
    v_dot2_f32_bf16 v229, v112, s37, v229
    v_dot2_f32_bf16 v230, v113, s36, v230
    v_dot2_f32_bf16 v231, v113, s37, v231
    v_dot2_f32_bf16 v232, v114, s36, v232
    v_dot2_f32_bf16 v233, v114, s37, v233
    v_dot2_f32_bf16 v234, v115, s36, v234
    v_dot2_f32_bf16 v235, v115, s37, v235
    s_waitcnt vmcnt(11)
    v_dot2_f32_bf16 v228, v116, s36, v228
    v_dot2_f32_bf16 v229, v116, s37, v229
    v_dot2_f32_bf16 v230, v117, s36, v230
    v_dot2_f32_bf16 v231, v117, s37, v231
    v_dot2_f32_bf16 v232, v118, s36, v232
    v_dot2_f32_bf16 v233, v118, s37, v233
    v_dot2_f32_bf16 v234, v119, s36, v234
    v_dot2_f32_bf16 v235, v119, s37, v235
    s_waitcnt vmcnt(10)
    v_dot2_f32_bf16 v228, v120, s36, v228
    v_dot2_f32_bf16 v229, v120, s37, v229
    v_dot2_f32_bf16 v230, v121, s36, v230
    v_dot2_f32_bf16 v231, v121, s37, v231
    v_dot2_f32_bf16 v232, v122, s36, v232
    v_dot2_f32_bf16 v233, v122, s37, v233
    v_dot2_f32_bf16 v234, v123, s36, v234
    v_dot2_f32_bf16 v235, v123, s37, v235
    s_waitcnt vmcnt(9)
    v_dot2_f32_bf16 v228, v124, s36, v228
    v_dot2_f32_bf16 v229, v124, s37, v229
    v_dot2_f32_bf16 v230, v125, s36, v230
    v_dot2_f32_bf16 v231, v125, s37, v231
    v_dot2_f32_bf16 v232, v126, s36, v232
    v_dot2_f32_bf16 v233, v126, s37, v233
    v_dot2_f32_bf16 v234, v127, s36, v234
    v_dot2_f32_bf16 v235, v127, s37, v235
    s_waitcnt lgkmcnt(6)
    v_add_f32 v220, v180, v204
    v_add_f32 v221, v179, v203
    v_add_f32 v222, v178, v202
    v_add_f32 v223, v177, v201
    v_add_f32 v224, v176, v200
    v_add_f32 v225, v175, v199
    v_add_f32 v226, v174, v198
    v_add_f32 v227, v173, v197
    s_waitcnt lgkmcnt(0)
    v_add_f32 v236, v192, v216
    v_add_f32 v237, v191, v215
    v_add_f32 v238, v190, v214
    v_add_f32 v239, v189, v213
    v_add_f32 v240, v188, v212
    v_add_f32 v241, v187, v211
    v_add_f32 v242, v186, v210
    v_add_f32 v243, v185, v209
    v_fma_f32 v220, v236, s33, v220
    v_fma_f32 v221, v237, s33, v221
    v_fma_f32 v222, v238, s33, v222
    v_fma_f32 v223, v239, s33, v223
    v_fma_f32 v224, v240, s33, v224
    v_fma_f32 v225, v241, s33, v225
    v_fma_f32 v226, v242, s33, v226
    v_fma_f32 v227, v243, s33, v227
    v_exp_f32 v236, -v228
    v_exp_f32 v237, -v229
    v_exp_f32 v238, -v230
    v_exp_f32 v239, -v231
    v_exp_f32 v240, -v232
    v_exp_f32 v241, -v233
    v_exp_f32 v242, -v234
    v_exp_f32 v243, -v235
    v_pk_mul_f32 v[220:221], v[220:221], v[228:229]
    v_pk_mul_f32 v[222:223], v[222:223], v[230:231]
    v_pk_mul_f32 v[224:225], v[224:225], v[232:233]
    v_pk_mul_f32 v[226:227], v[226:227], v[234:235]
    v_fma_f32 v236, v236, s38, s38
    v_fma_f32 v237, v237, s38, s38
    v_fma_f32 v238, v238, s38, s38
    v_fma_f32 v239, v239, s38, s38
    v_fma_f32 v240, v240, s38, s38
    v_fma_f32 v241, v241, s38, s38
    v_fma_f32 v242, v242, s38, s38
    v_fma_f32 v243, v243, s38, s38
    v_rcp_f32 v236, v236
    v_rcp_f32 v237, v237
    v_rcp_f32 v238, v238
    v_rcp_f32 v239, v239
    v_rcp_f32 v240, v240
    v_rcp_f32 v241, v241
    v_rcp_f32 v242, v242
    v_rcp_f32 v243, v243
    s_nop 0
    v_pk_mul_f32 v[220:221], v[220:221], v[236:237]
    v_pk_mul_f32 v[222:223], v[222:223], v[238:239]
    v_pk_mul_f32 v[224:225], v[224:225], v[240:241]
    v_pk_mul_f32 v[226:227], v[226:227], v[242:243]
    s_waitcnt vmcnt(27)
    v_dot2_f32_bf16 v220, v164, s36, v220
    v_dot2_f32_bf16 v221, v164, s37, v221
    v_dot2_f32_bf16 v222, v165, s36, v222
    v_dot2_f32_bf16 v223, v165, s37, v223
    v_dot2_f32_bf16 v224, v166, s36, v224
    v_dot2_f32_bf16 v225, v166, s37, v225
    v_dot2_f32_bf16 v226, v167, s36, v226
    v_dot2_f32_bf16 v227, v167, s37, v227
    v_cvt_pk_bf16_f32 v164, v220, v221
    v_cvt_pk_bf16_f32 v165, v222, v223
    v_cvt_pk_bf16_f32 v166, v224, v225
    v_cvt_pk_bf16_f32 v167, v226, v227
    buffer_store_dwordx4 v[164:167], v247, s[12:15], 0 offen offset:32
    ds_read_b128 v[172:175], v249 offset:0
    ds_read_b128 v[176:179], v249 offset:16
    ds_read_b128 v[180:183], v249 offset:32
    ds_read_b128 v[196:199], v249 offset:17408
    ds_read_b128 v[200:203], v249 offset:17424
    ds_read_b128 v[204:207], v249 offset:17440
    ds_read_b128 v[184:187], v249 offset:8704
    ds_read_b128 v[188:191], v249 offset:8720
    ds_read_b128 v[192:195], v249 offset:8736
    ds_read_b128 v[208:211], v249 offset:26112
    ds_read_b128 v[212:215], v249 offset:26128
    ds_read_b128 v[216:219], v249 offset:26144
    s_waitcnt vmcnt(9)
    v_dot2_f32_bf16 v228, v128, s36, 0
    v_dot2_f32_bf16 v229, v128, s37, 0
    v_dot2_f32_bf16 v230, v129, s36, 0
    v_dot2_f32_bf16 v231, v129, s37, 0
    v_dot2_f32_bf16 v232, v130, s36, 0
    v_dot2_f32_bf16 v233, v130, s37, 0
    v_dot2_f32_bf16 v234, v131, s36, 0
    v_dot2_f32_bf16 v235, v131, s37, 0
    s_waitcnt vmcnt(8)
    v_dot2_f32_bf16 v228, v132, s36, v228
    v_dot2_f32_bf16 v229, v132, s37, v229
    v_dot2_f32_bf16 v230, v133, s36, v230
    v_dot2_f32_bf16 v231, v133, s37, v231
    v_dot2_f32_bf16 v232, v134, s36, v232
    v_dot2_f32_bf16 v233, v134, s37, v233
    v_dot2_f32_bf16 v234, v135, s36, v234
    v_dot2_f32_bf16 v235, v135, s37, v235
    s_waitcnt vmcnt(7)
    v_dot2_f32_bf16 v228, v136, s36, v228
    v_dot2_f32_bf16 v229, v136, s37, v229
    v_dot2_f32_bf16 v230, v137, s36, v230
    v_dot2_f32_bf16 v231, v137, s37, v231
    v_dot2_f32_bf16 v232, v138, s36, v232
    v_dot2_f32_bf16 v233, v138, s37, v233
    v_dot2_f32_bf16 v234, v139, s36, v234
    v_dot2_f32_bf16 v235, v139, s37, v235
    s_waitcnt vmcnt(6)
    v_dot2_f32_bf16 v228, v140, s36, v228
    v_dot2_f32_bf16 v229, v140, s37, v229
    v_dot2_f32_bf16 v230, v141, s36, v230
    v_dot2_f32_bf16 v231, v141, s37, v231
    v_dot2_f32_bf16 v232, v142, s36, v232
    v_dot2_f32_bf16 v233, v142, s37, v233
    v_dot2_f32_bf16 v234, v143, s36, v234
    v_dot2_f32_bf16 v235, v143, s37, v235
    s_waitcnt vmcnt(5)
    v_dot2_f32_bf16 v228, v144, s36, v228
    v_dot2_f32_bf16 v229, v144, s37, v229
    v_dot2_f32_bf16 v230, v145, s36, v230
    v_dot2_f32_bf16 v231, v145, s37, v231
    v_dot2_f32_bf16 v232, v146, s36, v232
    v_dot2_f32_bf16 v233, v146, s37, v233
    v_dot2_f32_bf16 v234, v147, s36, v234
    v_dot2_f32_bf16 v235, v147, s37, v235
    s_waitcnt vmcnt(4)
    v_dot2_f32_bf16 v228, v148, s36, v228
    v_dot2_f32_bf16 v229, v148, s37, v229
    v_dot2_f32_bf16 v230, v149, s36, v230
    v_dot2_f32_bf16 v231, v149, s37, v231
    v_dot2_f32_bf16 v232, v150, s36, v232
    v_dot2_f32_bf16 v233, v150, s37, v233
    v_dot2_f32_bf16 v234, v151, s36, v234
    v_dot2_f32_bf16 v235, v151, s37, v235
    s_waitcnt vmcnt(3)
    v_dot2_f32_bf16 v228, v152, s36, v228
    v_dot2_f32_bf16 v229, v152, s37, v229
    v_dot2_f32_bf16 v230, v153, s36, v230
    v_dot2_f32_bf16 v231, v153, s37, v231
    v_dot2_f32_bf16 v232, v154, s36, v232
    v_dot2_f32_bf16 v233, v154, s37, v233
    v_dot2_f32_bf16 v234, v155, s36, v234
    v_dot2_f32_bf16 v235, v155, s37, v235
    s_waitcnt vmcnt(2)
    v_dot2_f32_bf16 v228, v156, s36, v228
    v_dot2_f32_bf16 v229, v156, s37, v229
    v_dot2_f32_bf16 v230, v157, s36, v230
    v_dot2_f32_bf16 v231, v157, s37, v231
    v_dot2_f32_bf16 v232, v158, s36, v232
    v_dot2_f32_bf16 v233, v158, s37, v233
    v_dot2_f32_bf16 v234, v159, s36, v234
    v_dot2_f32_bf16 v235, v159, s37, v235
    s_waitcnt lgkmcnt(6)
    v_add_f32 v220, v180, v204
    v_add_f32 v221, v179, v203
    v_add_f32 v222, v178, v202
    v_add_f32 v223, v177, v201
    v_add_f32 v224, v176, v200
    v_add_f32 v225, v175, v199
    v_add_f32 v226, v174, v198
    v_add_f32 v227, v173, v197
    s_waitcnt lgkmcnt(0)
    v_add_f32 v236, v192, v216
    v_add_f32 v237, v191, v215
    v_add_f32 v238, v190, v214
    v_add_f32 v239, v189, v213
    v_add_f32 v240, v188, v212
    v_add_f32 v241, v187, v211
    v_add_f32 v242, v186, v210
    v_add_f32 v243, v185, v209
    v_fma_f32 v220, v236, s33, v220
    v_fma_f32 v221, v237, s33, v221
    v_fma_f32 v222, v238, s33, v222
    v_fma_f32 v223, v239, s33, v223
    v_fma_f32 v224, v240, s33, v224
    v_fma_f32 v225, v241, s33, v225
    v_fma_f32 v226, v242, s33, v226
    v_fma_f32 v227, v243, s33, v227
    v_exp_f32 v236, -v228
    v_exp_f32 v237, -v229
    v_exp_f32 v238, -v230
    v_exp_f32 v239, -v231
    v_exp_f32 v240, -v232
    v_exp_f32 v241, -v233
    v_exp_f32 v242, -v234
    v_exp_f32 v243, -v235
    v_pk_mul_f32 v[220:221], v[220:221], v[228:229]
    v_pk_mul_f32 v[222:223], v[222:223], v[230:231]
    v_pk_mul_f32 v[224:225], v[224:225], v[232:233]
    v_pk_mul_f32 v[226:227], v[226:227], v[234:235]
    v_fma_f32 v236, v236, s38, s38
    v_fma_f32 v237, v237, s38, s38
    v_fma_f32 v238, v238, s38, s38
    v_fma_f32 v239, v239, s38, s38
    v_fma_f32 v240, v240, s38, s38
    v_fma_f32 v241, v241, s38, s38
    v_fma_f32 v242, v242, s38, s38
    v_fma_f32 v243, v243, s38, s38
    v_rcp_f32 v236, v236
    v_rcp_f32 v237, v237
    v_rcp_f32 v238, v238
    v_rcp_f32 v239, v239
    v_rcp_f32 v240, v240
    v_rcp_f32 v241, v241
    v_rcp_f32 v242, v242
    v_rcp_f32 v243, v243
    s_nop 0
    v_pk_mul_f32 v[220:221], v[220:221], v[236:237]
    v_pk_mul_f32 v[222:223], v[222:223], v[238:239]
    v_pk_mul_f32 v[224:225], v[224:225], v[240:241]
    v_pk_mul_f32 v[226:227], v[226:227], v[242:243]
    s_waitcnt vmcnt(27)
    v_dot2_f32_bf16 v220, v168, s36, v220
    v_dot2_f32_bf16 v221, v168, s37, v221
    v_dot2_f32_bf16 v222, v169, s36, v222
    v_dot2_f32_bf16 v223, v169, s37, v223
    v_dot2_f32_bf16 v224, v170, s36, v224
    v_dot2_f32_bf16 v225, v170, s37, v225
    v_dot2_f32_bf16 v226, v171, s36, v226
    v_dot2_f32_bf16 v227, v171, s37, v227
    v_cvt_pk_bf16_f32 v168, v220, v221
    v_cvt_pk_bf16_f32 v169, v222, v223
    v_cvt_pk_bf16_f32 v170, v224, v225
    v_cvt_pk_bf16_f32 v171, v226, v227
    buffer_store_dwordx4 v[168:171], v247, s[12:15], 0 offen offset:64
L_recurrent_scan__spectral_fnet__swiglu_ffn__prompt_kernel_done_18:
L_recurrent_scan__spectral_fnet__swiglu_ffn__prompt_kernel_fin_10:
    s_waitcnt vmcnt(0)
L_recurrent_scan__spectral_fnet__swiglu_ffn__prompt_kernel_end_1:
    s_endpgm
.section .rodata,"a"
.p2align 6
.amdhsa_kernel recurrent_scan__spectral_fnet__swiglu_ffn__prompt_kernel
  .amdhsa_next_free_vgpr 512
  .amdhsa_next_free_sgpr 102
  .amdhsa_accum_offset 256
  .amdhsa_group_segment_fixed_size 0
  .amdhsa_kernarg_size 96
  .amdhsa_user_sgpr_count 2
  .amdhsa_user_sgpr_kernarg_segment_ptr 1
  .amdhsa_system_sgpr_workgroup_id_x 1
  .amdhsa_float_denorm_mode_32 3
  .amdhsa_float_denorm_mode_16_64 3
  .amdhsa_ieee_mode 0
  .amdhsa_dx10_clamp 1
.end_amdhsa_kernel
```
